```python
import torch

def _softmax(x, axis=-1):
    return torch.softmax(x, dim=axis)
def _gelu(x):
    return torch.nn.functional.gelu(x, approximate="tanh")
def _silu(x):
    return torch.nn.functional.silu(x)
def _sigmoid(x):
    return torch.sigmoid(x)
def _layernorm(x, axis=-1, eps=1e-5):
    m = x.mean(dim=axis, keepdim=True)
    v = x.var(dim=axis, keepdim=True, unbiased=False)
    return (x - m) / torch.sqrt(v + eps)
def _scatter_add(tgt, idx, src, axis=0):
    return tgt.clone().index_add_(axis, idx, src)
def _segment_sum(src, seg, n):
    out = torch.zeros((n,) + src.shape[1:], dtype=src.dtype)
    return out.index_add_(0, seg, src)
def _pad(x, pw):
    flat = tuple(v for pair in reversed(pw) for v in pair)
    return torch.nn.functional.pad(x, flat)

kernel_name = 'standalone__kv_cache_quant_int4_int2_kv_with_per_channel_or_per_token_scales__sampling'

def setup_inputs():

    _w = (lambda a: (lambda t: t.to(torch.bfloat16) if t.is_floating_point() else t)(torch.as_tensor(a)))
    B = 8
    Sq = 32
    Skv = 8192
    Hq = 32
    Hkv = 8
    Dh = 128
    bits = 4
    G = 64
    if G <= 0 or G >= Skv:
        G = max(1, Skv // 2)
    Skv = (Skv // G) * G
    ngk = Skv // G
    qmax = (1 << bits) - 1
    return {
        "q": _w((lambda *s: torch.randn(*s, dtype=torch.bfloat16) * 1.6)(B, Hq, Sq, Dh)),
        "qk": _w(torch.randint(0, qmax + 1, (B, Hkv, Skv, Dh)).to(torch.int32)),
        "qv": _w(torch.randint(0, qmax + 1, (B, Hkv, Skv, Dh)).to(torch.int32)),
        "k_scales": _w(torch.abs((lambda *s: torch.randn(*s, dtype=torch.bfloat16) * 1.6)(B, Hkv, ngk, Dh)) * 0.05 + 0.02),
        "k_zeros": _w((lambda *s: torch.randn(*s, dtype=torch.bfloat16) * 1.6)(B, Hkv, ngk, Dh) + float(qmax) / 2.0),
        "v_scales": _w(torch.abs((lambda *s: torch.randn(*s, dtype=torch.bfloat16) * 0.05)(B, Hkv, Skv, 1)) * 0.05 + 0.02),
        "v_zeros": _w((lambda *s: torch.randn(*s, dtype=torch.bfloat16) * 0.05)(B, Hkv, Skv, 1) + float(qmax) / 2.0),
    }

def reference(q, qk, qv, k_scales, k_zeros, v_scales, v_zeros):
    B, Hq, Sq, Dh = q.shape
    Hkv, Skv = qk.shape[1], qk.shape[2]
    ngk = k_scales.shape[2]
    G = Skv // ngk
    ks = (lambda x, n, axis: torch.repeat_interleave(x, n, dim=axis))(k_scales, G, axis=2)
    kz = (lambda x, n, axis: torch.repeat_interleave(x, n, dim=axis))(k_zeros, G, axis=2)
    k = ((lambda x, dt: x.to(dt))(qk, q.dtype) - kz) * ks
    v = ((lambda x, dt: x.to(dt))(qv, q.dtype) - v_zeros) * v_scales
    rep = Hq // Hkv
    if rep > 1:
        k = (lambda x, n, axis: torch.repeat_interleave(x, n, dim=axis))(k, rep, axis=1)
        v = (lambda x, n, axis: torch.repeat_interleave(x, n, dim=axis))(v, rep, axis=1)
    scale = float(Dh) ** -0.5
    logits = torch.einsum("bhqd,bhkd->bhqk", q, k) * scale
    p = _softmax(logits, axis=-1)
    o = torch.einsum("bhqk,bhkd->bhqd", p, v)
    return o
```

```asm
; @launch grid=(256,1,1) block=(512,1,1) lds=138304
.amdgcn_target "amdgcn-amd-amdhsa--gfx950"
.text
.globl standalone__kv_cache_quant_int4_int2_kv_with_per_channel_or_per_token_scales__sampling_kernel
.p2align 8
.type standalone__kv_cache_quant_int4_int2_kv_with_per_channel_or_per_token_scales__sampling_kernel,@function
standalone__kv_cache_quant_int4_int2_kv_with_per_channel_or_per_token_scales__sampling_kernel:
s_cmp_ge_u32 s2, 256
s_cbranch_scc1 L_end
s_load_dwordx16 s[4:19], s[0:1], 0
s_load_dwordx4 s[20:23], s[0:1], 64
v_lshrrev_b32 v224, 6, v0
v_and_b32 v238, 63, v0
v_mov_b32 v239, v0
v_readfirstlane_b32 s3, v224
v_and_b32 v240, 31, v0
v_bfe_u32 v241, v0, 5, 1
s_lshr_b32 s36, s2, 2
s_and_b32 s37, s2, 3
s_and_b32 s38, s3, 3
s_lshr_b32 s39, s3, 2
s_lshl_b32 s58, s2, 20
s_lshl_b32 s60, s38, 13
s_movk_i32 s80, 272
s_cmp_eq_u32 s39, 0
s_cbranch_scc0 L_v0
v_lshlrev_b32 v236, 4, v238
s_branch L_v1
L_v0:
v_lshlrev_b32 v236, 4, v240
v_lshl_add_u32 v236, v241, 11, v236
L_v1:
v_add_u32 v236, s60, v236
v_add_u32 v237, 4096, v236
s_waitcnt lgkmcnt(0)
s_cmp_eq_u32 s39, 0
s_cselect_b32 s24, s6, s8
s_cselect_b32 s25, s7, s9
s_add_u32 s24, s24, s58
s_addc_u32 s25, s25, 0
s_mov_b32 s26, 0x100000
s_mov_b32 s27, 0x20000
s_cmp_eq_u32 s39, 0
s_cbranch_scc0 L_V_entry
L_K_entry:
buffer_load_dwordx4 v[152:155], v236, s[24:27], 0 offen offset:0 nt
buffer_load_dwordx4 v[156:159], v236, s[24:27], 0 offen offset:1024 nt
buffer_load_dwordx4 v[160:163], v236, s[24:27], 0 offen offset:2048 nt
buffer_load_dwordx4 v[164:167], v236, s[24:27], 0 offen offset:3072 nt
v_add_u32 v236, 0x8000, v236
buffer_load_dwordx4 v[168:171], v237, s[24:27], 0 offen offset:0 nt
buffer_load_dwordx4 v[172:175], v237, s[24:27], 0 offen offset:1024 nt
buffer_load_dwordx4 v[176:179], v237, s[24:27], 0 offen offset:2048 nt
buffer_load_dwordx4 v[180:183], v237, s[24:27], 0 offen offset:3072 nt
v_add_u32 v237, 0x8000, v237
s_lshl_b32 s43, s36, 15
s_lshl_b32 s56, s2, 13
s_lshl_b32 s57, s2, 12
s_add_u32 s28, s10, s56
s_addc_u32 s29, s11, 0
s_mov_b32 s30, 8192
s_mov_b32 s31, 0x20000
s_add_u32 s32, s12, s56
s_addc_u32 s33, s13, 0
s_mov_b32 s34, 8192
s_mov_b32 s35, 0x20000
s_add_u32 s84, s14, s57
s_addc_u32 s85, s15, 0
s_mov_b32 s86, 4096
s_mov_b32 s87, 0x20000
s_add_u32 s48, s16, s57
s_addc_u32 s49, s17, 0
s_mov_b32 s50, 4096
s_mov_b32 s51, 0x20000
s_add_u32 s52, s4, s43
s_addc_u32 s53, s5, 0
s_mov_b32 s54, 32768
s_mov_b32 s55, 0x20000
v_lshlrev_b32 v228, 4, v239
v_lshlrev_b32 v229, 3, v239
buffer_load_dwordx4 v[112:115], v228, s[28:31], 0 offen nt
buffer_load_dwordx4 v[116:119], v228, s[32:35], 0 offen nt
buffer_load_dwordx2 v[120:121], v229, s[84:87], 0 offen nt
buffer_load_dwordx2 v[122:123], v229, s[48:51], 0 offen nt
v_lshlrev_b32 v226, 4, v238
s_lshl_b32 s60, s3, 12
v_add_u32 v226, s60, v226
buffer_load_dwordx4 v[64:67], v226, s[52:55], 0 offen offset:0 nt
buffer_load_dwordx4 v[68:71], v226, s[52:55], 0 offen offset:1024 nt
buffer_load_dwordx4 v[72:75], v226, s[52:55], 0 offen offset:2048 nt
buffer_load_dwordx4 v[76:79], v226, s[52:55], 0 offen offset:3072 nt
buffer_load_dwordx4 v[184:187], v236, s[24:27], 0 offen offset:0 nt
buffer_load_dwordx4 v[188:191], v236, s[24:27], 0 offen offset:1024 nt
buffer_load_dwordx4 v[192:195], v236, s[24:27], 0 offen offset:2048 nt
buffer_load_dwordx4 v[196:199], v236, s[24:27], 0 offen offset:3072 nt
v_add_u32 v236, 0x8000, v236
s_mov_b32 s40, 0x3e0293ee
s_mov_b32 s41, 0x3e0293ee
s_mov_b32 s44, 0xbe0293ee
s_mov_b32 s45, 0x427af233
s_lshl_b32 s56, s36, 2
s_add_u32 s62, s20, s56
s_addc_u32 s63, s21, 0
s_mov_b32 s42, 15
s_lshl_b32 s60, s39, 5
v_add_u32 v227, s60, v240
v_mul_lo_u32 v232, v227, s80
v_lshl_add_u32 v232, v241, 4, v232
s_lshl_b32 s60, s39, 13
v_lshlrev_b32 v233, 4, v238
v_add_u32 v233, s60, v233
s_lshl_b32 s60, s38, 4
v_add_u32 v227, s60, v241
v_mul_lo_u32 v234, v227, s80
v_lshl_add_u32 v234, v240, 3, v234
v_lshlrev_b32 v235, 4, v240
v_add_u32 v235, 68608, v235
v_mov_b32 v0, 0
v_mov_b32 v1, 0
v_mov_b32 v2, 0
v_mov_b32 v3, 0
v_mov_b32 v4, 0
v_mov_b32 v5, 0
v_mov_b32 v6, 0
v_mov_b32 v7, 0
v_mov_b32 v8, 0
v_mov_b32 v9, 0
v_mov_b32 v10, 0
v_mov_b32 v11, 0
v_mov_b32 v12, 0
v_mov_b32 v13, 0
v_mov_b32 v14, 0
v_mov_b32 v15, 0
v_mov_b32 v16, 0
v_mov_b32 v17, 0
v_mov_b32 v18, 0
v_mov_b32 v19, 0
v_mov_b32 v20, 0
v_mov_b32 v21, 0
v_mov_b32 v22, 0
v_mov_b32 v23, 0
v_mov_b32 v24, 0
v_mov_b32 v25, 0
v_mov_b32 v26, 0
v_mov_b32 v27, 0
v_mov_b32 v28, 0
v_mov_b32 v29, 0
v_mov_b32 v30, 0
v_mov_b32 v31, 0
v_mov_b32 v32, 0
v_mov_b32 v33, 0
v_mov_b32 v34, 0
v_mov_b32 v35, 0
v_mov_b32 v36, 0
v_mov_b32 v37, 0
v_mov_b32 v38, 0
v_mov_b32 v39, 0
v_mov_b32 v40, 0
v_mov_b32 v41, 0
v_mov_b32 v42, 0
v_mov_b32 v43, 0
v_mov_b32 v44, 0
v_mov_b32 v45, 0
v_mov_b32 v46, 0
v_mov_b32 v47, 0
v_mov_b32 v48, 0
v_mov_b32 v49, 0
v_mov_b32 v50, 0
v_mov_b32 v51, 0
v_mov_b32 v52, 0
v_mov_b32 v53, 0
v_mov_b32 v54, 0
v_mov_b32 v55, 0
v_mov_b32 v56, 0
v_mov_b32 v57, 0
v_mov_b32 v58, 0
v_mov_b32 v59, 0
v_mov_b32 v60, 0
v_mov_b32 v61, 0
v_mov_b32 v62, 0
v_mov_b32 v63, 0
v_mov_b32 v216, 0xff61b1e6
v_mov_b32 v221, 0xff61b1e6
v_mov_b32 v220, 0
v_mov_b32 v218, 0
v_mov_b32 v219, 0
v_mov_b32 v250, 138240
v_mov_b32 v252, 0
v_lshrrev_b32 v224, 4, v239
v_and_b32 v225, 15, v239
v_lshlrev_b32 v242, 10, v224
v_lshl_add_u32 v242, v225, 5, v242
v_add_u32 v242, 68608, v242
v_lshlrev_b32 v243, 5, v239
v_add_u32 v243, 101376, v243
v_lshrrev_b32 v224, 4, v238
s_lshl_b32 s60, s3, 4
v_add_u32 v224, s60, v224
v_mul_lo_u32 v244, v224, s80
v_lshl_add_u32 v244, v225, 4, v244
v_add_u32 v244, 33792, v244
s_lshl_b32 s60, s38, 5
v_add_u32 v224, s60, v240
v_mul_lo_u32 v245, v224, s80
v_lshl_add_u32 v245, v241, 4, v245
v_add_u32 v245, 33792, v245
s_waitcnt vmcnt(4)
v_lshlrev_b32 v96, 16, v112
v_and_b32 v97, 0xffff0000, v112
v_lshlrev_b32 v226, 16, v116
v_and_b32 v227, 0xffff0000, v116
v_mul_f32 v104, -v226, v96
v_mul_f32 v105, -v227, v97
v_lshlrev_b32 v98, 16, v113
v_and_b32 v99, 0xffff0000, v113
v_lshlrev_b32 v226, 16, v117
v_and_b32 v227, 0xffff0000, v117
v_mul_f32 v106, -v226, v98
v_mul_f32 v107, -v227, v99
v_lshlrev_b32 v100, 16, v114
v_and_b32 v101, 0xffff0000, v114
v_lshlrev_b32 v226, 16, v118
v_and_b32 v227, 0xffff0000, v118
v_mul_f32 v108, -v226, v100
v_mul_f32 v109, -v227, v101
v_lshlrev_b32 v102, 16, v115
v_and_b32 v103, 0xffff0000, v115
v_lshlrev_b32 v226, 16, v119
v_and_b32 v227, 0xffff0000, v119
v_mul_f32 v110, -v226, v102
v_mul_f32 v111, -v227, v103
ds_write_b128 v242, v[96:99]
ds_write_b128 v242, v[100:103] offset:16
ds_write_b128 v242, v[104:107] offset:512
ds_write_b128 v242, v[108:111] offset:528
s_waitcnt vmcnt(2)
buffer_load_dwordx4 v[200:203], v237, s[24:27], 0 offen offset:0 nt
v_lshlrev_b32 v144, 16, v120
v_and_b32 v145, 0xffff0000, v120
v_lshlrev_b32 v226, 16, v122
v_and_b32 v227, 0xffff0000, v122
v_mul_f32 v148, -v226, v144
v_mul_f32 v149, -v227, v145
v_lshlrev_b32 v146, 16, v121
v_and_b32 v147, 0xffff0000, v121
v_lshlrev_b32 v226, 16, v123
v_and_b32 v227, 0xffff0000, v123
v_mul_f32 v150, -v226, v146
v_mul_f32 v151, -v227, v147
ds_write_b128 v243, v[144:147]
ds_write_b128 v243, v[148:151] offset:16
ds_write_b128 v244, v[64:67] offset:0
ds_write_b128 v244, v[68:71] offset:1088
ds_write_b128 v244, v[72:75] offset:2176
ds_write_b128 v244, v[76:79] offset:3264
s_waitcnt vmcnt(2)
buffer_load_dwordx4 v[204:207], v237, s[24:27], 0 offen offset:1024 nt
s_waitcnt lgkmcnt(0)
s_barrier
ds_read_b128 v[64:67], v245 offset:0
ds_read_b128 v[68:71], v245 offset:32
ds_read_b128 v[72:75], v245 offset:64
ds_read_b128 v[76:79], v245 offset:96
ds_read_b128 v[80:83], v245 offset:128
ds_read_b128 v[84:87], v245 offset:160
ds_read_b128 v[88:91], v245 offset:192
ds_read_b128 v[92:95], v245 offset:224
ds_read_b128 v[96:99], v235
ds_read_b128 v[100:103], v235 offset:512
v_add_u32 v235, 1024, v235
s_waitcnt vmcnt(6) lgkmcnt(0)
v_cvt_f32_i32 v152, v152
v_cvt_f32_i32 v153, v153
v_cvt_f32_i32 v154, v154
v_cvt_f32_i32 v155, v155
v_pk_fma_f32 v[152:153], v[152:153], v[96:97], v[100:101]
v_pk_fma_f32 v[154:155], v[154:155], v[98:99], v[102:103]
v_cvt_pk_bf16_f32 v112, v152, v153
v_cvt_pk_bf16_f32 v113, v154, v155
ds_write_b64 v234, v[112:113] offset:0
v_cvt_f32_i32 v156, v156
v_cvt_f32_i32 v157, v157
v_cvt_f32_i32 v158, v158
v_cvt_f32_i32 v159, v159
v_pk_fma_f32 v[156:157], v[156:157], v[96:97], v[100:101]
v_pk_fma_f32 v[158:159], v[158:159], v[98:99], v[102:103]
v_cvt_pk_bf16_f32 v114, v156, v157
v_cvt_pk_bf16_f32 v115, v158, v159
ds_write_b64 v234, v[114:115] offset:544
s_waitcnt vmcnt(2)
buffer_load_dwordx4 v[208:211], v237, s[24:27], 0 offen offset:2048 nt
v_cvt_f32_i32 v160, v160
v_cvt_f32_i32 v161, v161
v_cvt_f32_i32 v162, v162
v_cvt_f32_i32 v163, v163
v_pk_fma_f32 v[160:161], v[160:161], v[96:97], v[100:101]
v_pk_fma_f32 v[162:163], v[162:163], v[98:99], v[102:103]
v_cvt_pk_bf16_f32 v116, v160, v161
v_cvt_pk_bf16_f32 v117, v162, v163
ds_write_b64 v234, v[116:117] offset:1088
v_cvt_f32_i32 v164, v164
v_cvt_f32_i32 v165, v165
v_cvt_f32_i32 v166, v166
v_cvt_f32_i32 v167, v167
v_pk_fma_f32 v[164:165], v[164:165], v[96:97], v[100:101]
v_pk_fma_f32 v[166:167], v[166:167], v[98:99], v[102:103]
v_cvt_pk_bf16_f32 v118, v164, v165
v_cvt_pk_bf16_f32 v119, v166, v167
ds_write_b64 v234, v[118:119] offset:1632
v_cvt_f32_i32 v168, v168
v_cvt_f32_i32 v169, v169
v_cvt_f32_i32 v170, v170
v_cvt_f32_i32 v171, v171
v_pk_fma_f32 v[168:169], v[168:169], v[96:97], v[100:101]
v_pk_fma_f32 v[170:171], v[170:171], v[98:99], v[102:103]
v_cvt_pk_bf16_f32 v120, v168, v169
v_cvt_pk_bf16_f32 v121, v170, v171
ds_write_b64 v234, v[120:121] offset:2176
v_cvt_f32_i32 v172, v172
v_cvt_f32_i32 v173, v173
v_cvt_f32_i32 v174, v174
v_cvt_f32_i32 v175, v175
v_pk_fma_f32 v[172:173], v[172:173], v[96:97], v[100:101]
v_pk_fma_f32 v[174:175], v[174:175], v[98:99], v[102:103]
v_cvt_pk_bf16_f32 v122, v172, v173
v_cvt_pk_bf16_f32 v123, v174, v175
ds_write_b64 v234, v[122:123] offset:2720
s_waitcnt vmcnt(2)
buffer_load_dwordx4 v[212:215], v237, s[24:27], 0 offen offset:3072 nt
v_add_u32 v237, 0x8000, v237
v_cvt_f32_i32 v176, v176
v_cvt_f32_i32 v177, v177
v_cvt_f32_i32 v178, v178
v_cvt_f32_i32 v179, v179
v_pk_fma_f32 v[176:177], v[176:177], v[96:97], v[100:101]
v_pk_fma_f32 v[178:179], v[178:179], v[98:99], v[102:103]
v_cvt_pk_bf16_f32 v124, v176, v177
v_cvt_pk_bf16_f32 v125, v178, v179
ds_write_b64 v234, v[124:125] offset:3264
v_cvt_f32_i32 v180, v180
v_cvt_f32_i32 v181, v181
v_cvt_f32_i32 v182, v182
v_cvt_f32_i32 v183, v183
v_pk_fma_f32 v[180:181], v[180:181], v[96:97], v[100:101]
v_pk_fma_f32 v[182:183], v[182:183], v[98:99], v[102:103]
v_cvt_pk_bf16_f32 v126, v180, v181
v_cvt_pk_bf16_f32 v127, v182, v183
ds_write_b64 v234, v[126:127] offset:3808
s_waitcnt lgkmcnt(0)
s_barrier
L_K_loop:
ds_read_b128 v[112:115], v232 offset:0
ds_read_b128 v[116:119], v232 offset:32
ds_read_b128 v[120:123], v232 offset:64
ds_read_b128 v[124:127], v232 offset:96
ds_read_b128 v[128:131], v232 offset:128
ds_read_b128 v[132:135], v232 offset:160
ds_read_b128 v[136:139], v232 offset:192
ds_read_b128 v[140:143], v232 offset:224
s_waitcnt vmcnt(2)
buffer_load_dwordx4 v[152:155], v236, s[24:27], 0 offen offset:0 nt
s_waitcnt lgkmcnt(7)
v_mfma_f32_32x32x16_bf16 v[96:111], v[112:115], v[64:67], 0
s_waitcnt lgkmcnt(6)
v_mfma_f32_32x32x16_bf16 v[96:111], v[116:119], v[68:71], v[96:111]
s_waitcnt lgkmcnt(5)
v_mfma_f32_32x32x16_bf16 v[96:111], v[120:123], v[72:75], v[96:111]
s_waitcnt lgkmcnt(4)
v_mfma_f32_32x32x16_bf16 v[96:111], v[124:127], v[76:79], v[96:111]
s_waitcnt lgkmcnt(3)
v_mfma_f32_32x32x16_bf16 v[96:111], v[128:131], v[80:83], v[96:111]
s_waitcnt lgkmcnt(2)
v_mfma_f32_32x32x16_bf16 v[96:111], v[132:135], v[84:87], v[96:111]
s_waitcnt lgkmcnt(1)
v_mfma_f32_32x32x16_bf16 v[96:111], v[136:139], v[88:91], v[96:111]
s_waitcnt lgkmcnt(0)
v_mfma_f32_32x32x16_bf16 v[96:111], v[140:143], v[92:95], v[96:111]
ds_read_b128 v[112:115], v233 offset:17408
ds_read_b128 v[116:119], v233 offset:18432
ds_read_b128 v[120:123], v233 offset:19456
ds_read_b128 v[124:127], v233 offset:20480
ds_read_b128 v[128:131], v233 offset:21504
ds_read_b128 v[132:135], v233 offset:22528
ds_read_b128 v[136:139], v233 offset:23552
ds_read_b128 v[140:143], v233 offset:24576
s_waitcnt vmcnt(2)
buffer_load_dwordx4 v[156:159], v236, s[24:27], 0 offen offset:1024 nt
s_nop 1
v_max3_f32 v224, v96, v97, v98
v_max3_f32 v225, v99, v100, v101
v_max3_f32 v226, v102, v103, v104
v_max3_f32 v227, v105, v106, v107
v_max3_f32 v224, v224, v108, v109
v_max3_f32 v225, v225, v110, v111
v_max3_f32 v224, v224, v226, v227
v_max_f32 v224, v224, v225
v_cmp_gt_f32 vcc, v224, v221
s_nop 1
s_cbranch_vccz L_nr1
v_max_f32 v224, v224, v216
v_mov_b32 v225, v224
s_nop 1
v_permlane32_swap_b32 v224, v225
s_nop 0
v_max_f32 v224, v224, v225
v_sub_f32 v226, v216, v224
v_mul_f32 v226, s40, v226
v_mul_f32 v220, s44, v224
v_exp_f32 v222, v226
v_mov_b32 v216, v224
v_add_f32 v221, s45, v224
v_pk_mul_f32 v[218:219], v[218:219], v[222:223] op_sel_hi:[1,0]
v_pk_mul_f32 v[0:1], v[0:1], v[222:223] op_sel_hi:[1,0]
v_pk_mul_f32 v[2:3], v[2:3], v[222:223] op_sel_hi:[1,0]
v_pk_mul_f32 v[4:5], v[4:5], v[222:223] op_sel_hi:[1,0]
v_pk_mul_f32 v[6:7], v[6:7], v[222:223] op_sel_hi:[1,0]
v_pk_mul_f32 v[8:9], v[8:9], v[222:223] op_sel_hi:[1,0]
v_pk_mul_f32 v[10:11], v[10:11], v[222:223] op_sel_hi:[1,0]
v_pk_mul_f32 v[12:13], v[12:13], v[222:223] op_sel_hi:[1,0]
v_pk_mul_f32 v[14:15], v[14:15], v[222:223] op_sel_hi:[1,0]
v_pk_mul_f32 v[16:17], v[16:17], v[222:223] op_sel_hi:[1,0]
v_pk_mul_f32 v[18:19], v[18:19], v[222:223] op_sel_hi:[1,0]
v_pk_mul_f32 v[20:21], v[20:21], v[222:223] op_sel_hi:[1,0]
v_pk_mul_f32 v[22:23], v[22:23], v[222:223] op_sel_hi:[1,0]
v_pk_mul_f32 v[24:25], v[24:25], v[222:223] op_sel_hi:[1,0]
v_pk_mul_f32 v[26:27], v[26:27], v[222:223] op_sel_hi:[1,0]
v_pk_mul_f32 v[28:29], v[28:29], v[222:223] op_sel_hi:[1,0]
v_pk_mul_f32 v[30:31], v[30:31], v[222:223] op_sel_hi:[1,0]
v_pk_mul_f32 v[32:33], v[32:33], v[222:223] op_sel_hi:[1,0]
v_pk_mul_f32 v[34:35], v[34:35], v[222:223] op_sel_hi:[1,0]
v_pk_mul_f32 v[36:37], v[36:37], v[222:223] op_sel_hi:[1,0]
v_pk_mul_f32 v[38:39], v[38:39], v[222:223] op_sel_hi:[1,0]
v_pk_mul_f32 v[40:41], v[40:41], v[222:223] op_sel_hi:[1,0]
v_pk_mul_f32 v[42:43], v[42:43], v[222:223] op_sel_hi:[1,0]
v_pk_mul_f32 v[44:45], v[44:45], v[222:223] op_sel_hi:[1,0]
v_pk_mul_f32 v[46:47], v[46:47], v[222:223] op_sel_hi:[1,0]
v_pk_mul_f32 v[48:49], v[48:49], v[222:223] op_sel_hi:[1,0]
v_pk_mul_f32 v[50:51], v[50:51], v[222:223] op_sel_hi:[1,0]
v_pk_mul_f32 v[52:53], v[52:53], v[222:223] op_sel_hi:[1,0]
v_pk_mul_f32 v[54:55], v[54:55], v[222:223] op_sel_hi:[1,0]
v_pk_mul_f32 v[56:57], v[56:57], v[222:223] op_sel_hi:[1,0]
v_pk_mul_f32 v[58:59], v[58:59], v[222:223] op_sel_hi:[1,0]
v_pk_mul_f32 v[60:61], v[60:61], v[222:223] op_sel_hi:[1,0]
v_pk_mul_f32 v[62:63], v[62:63], v[222:223] op_sel_hi:[1,0]
L_nr1:
v_pk_fma_f32 v[96:97], v[96:97], s[40:41], v[220:221] op_sel_hi:[1,1,0]
v_pk_fma_f32 v[98:99], v[98:99], s[40:41], v[220:221] op_sel_hi:[1,1,0]
v_pk_fma_f32 v[100:101], v[100:101], s[40:41], v[220:221] op_sel_hi:[1,1,0]
v_pk_fma_f32 v[102:103], v[102:103], s[40:41], v[220:221] op_sel_hi:[1,1,0]
v_pk_fma_f32 v[104:105], v[104:105], s[40:41], v[220:221] op_sel_hi:[1,1,0]
v_pk_fma_f32 v[106:107], v[106:107], s[40:41], v[220:221] op_sel_hi:[1,1,0]
v_pk_fma_f32 v[108:109], v[108:109], s[40:41], v[220:221] op_sel_hi:[1,1,0]
v_pk_fma_f32 v[110:111], v[110:111], s[40:41], v[220:221] op_sel_hi:[1,1,0]
v_exp_f32 v96, v96
v_exp_f32 v97, v97
v_exp_f32 v98, v98
v_exp_f32 v99, v99
v_exp_f32 v100, v100
v_exp_f32 v101, v101
v_exp_f32 v102, v102
v_exp_f32 v103, v103
v_exp_f32 v104, v104
v_exp_f32 v105, v105
v_exp_f32 v106, v106
v_exp_f32 v107, v107
v_exp_f32 v108, v108
v_exp_f32 v109, v109
v_exp_f32 v110, v110
v_exp_f32 v111, v111
s_waitcnt vmcnt(2)
buffer_load_dwordx4 v[160:163], v236, s[24:27], 0 offen offset:2048 nt
v_cvt_pk_bf16_f32 v144, v96, v97
v_cvt_pk_bf16_f32 v145, v98, v99
v_cvt_pk_bf16_f32 v146, v100, v101
v_cvt_pk_bf16_f32 v147, v102, v103
v_cvt_pk_bf16_f32 v148, v104, v105
v_cvt_pk_bf16_f32 v149, v106, v107
v_cvt_pk_bf16_f32 v150, v108, v109
v_cvt_pk_bf16_f32 v151, v110, v111
v_pk_add_f32 v[224:225], v[96:97], v[98:99]
v_pk_add_f32 v[226:227], v[100:101], v[102:103]
v_pk_add_f32 v[228:229], v[104:105], v[106:107]
v_pk_add_f32 v[230:231], v[108:109], v[110:111]
v_pk_add_f32 v[224:225], v[224:225], v[226:227]
v_pk_add_f32 v[228:229], v[228:229], v[230:231]
ds_read_b128 v[96:99], v235
ds_read_b128 v[100:103], v235 offset:512
v_add_u32 v235, 1024, v235
s_waitcnt vmcnt(2)
buffer_load_dwordx4 v[164:167], v236, s[24:27], 0 offen offset:3072 nt
v_add_u32 v236, 0x8000, v236
s_waitcnt lgkmcnt(2)
v_mfma_f32_32x32x16_bf16 v[0:15], v[112:115], v[144:147], v[0:15]
v_mfma_f32_32x32x16_bf16 v[16:31], v[116:119], v[144:147], v[16:31]
v_mfma_f32_32x32x16_bf16 v[32:47], v[120:123], v[144:147], v[32:47]
v_mfma_f32_32x32x16_bf16 v[48:63], v[124:127], v[144:147], v[48:63]
v_pk_add_f32 v[224:225], v[224:225], v[228:229]
v_pk_add_f32 v[218:219], v[218:219], v[224:225]
v_mfma_f32_32x32x16_bf16 v[0:15], v[128:131], v[148:151], v[0:15]
v_mfma_f32_32x32x16_bf16 v[16:31], v[132:135], v[148:151], v[16:31]
v_mfma_f32_32x32x16_bf16 v[32:47], v[136:139], v[148:151], v[32:47]
v_mfma_f32_32x32x16_bf16 v[48:63], v[140:143], v[148:151], v[48:63]
s_waitcnt vmcnt(2)
buffer_load_dwordx4 v[168:171], v237, s[24:27], 0 offen offset:0 nt
s_waitcnt vmcnt(5) lgkmcnt(0)
v_cvt_f32_i32 v184, v184
v_cvt_f32_i32 v185, v185
v_cvt_f32_i32 v186, v186
v_cvt_f32_i32 v187, v187
v_pk_fma_f32 v[184:185], v[184:185], v[96:97], v[100:101]
v_pk_fma_f32 v[186:187], v[186:187], v[98:99], v[102:103]
v_cvt_pk_bf16_f32 v112, v184, v185
v_cvt_pk_bf16_f32 v113, v186, v187
ds_write_b64 v234, v[112:113] offset:33792
v_cvt_f32_i32 v188, v188
v_cvt_f32_i32 v189, v189
v_cvt_f32_i32 v190, v190
v_cvt_f32_i32 v191, v191
v_pk_fma_f32 v[188:189], v[188:189], v[96:97], v[100:101]
v_pk_fma_f32 v[190:191], v[190:191], v[98:99], v[102:103]
v_cvt_pk_bf16_f32 v114, v188, v189
v_cvt_pk_bf16_f32 v115, v190, v191
ds_write_b64 v234, v[114:115] offset:34336
s_waitcnt vmcnt(2)
buffer_load_dwordx4 v[172:175], v237, s[24:27], 0 offen offset:1024 nt
v_cvt_f32_i32 v192, v192
v_cvt_f32_i32 v193, v193
v_cvt_f32_i32 v194, v194
v_cvt_f32_i32 v195, v195
v_pk_fma_f32 v[192:193], v[192:193], v[96:97], v[100:101]
v_pk_fma_f32 v[194:195], v[194:195], v[98:99], v[102:103]
v_cvt_pk_bf16_f32 v116, v192, v193
v_cvt_pk_bf16_f32 v117, v194, v195
ds_write_b64 v234, v[116:117] offset:34880
v_cvt_f32_i32 v196, v196
v_cvt_f32_i32 v197, v197
v_cvt_f32_i32 v198, v198
v_cvt_f32_i32 v199, v199
v_pk_fma_f32 v[196:197], v[196:197], v[96:97], v[100:101]
v_pk_fma_f32 v[198:199], v[198:199], v[98:99], v[102:103]
v_cvt_pk_bf16_f32 v118, v196, v197
v_cvt_pk_bf16_f32 v119, v198, v199
ds_write_b64 v234, v[118:119] offset:35424
v_cvt_f32_i32 v200, v200
v_cvt_f32_i32 v201, v201
v_cvt_f32_i32 v202, v202
v_cvt_f32_i32 v203, v203
v_pk_fma_f32 v[200:201], v[200:201], v[96:97], v[100:101]
v_pk_fma_f32 v[202:203], v[202:203], v[98:99], v[102:103]
v_cvt_pk_bf16_f32 v120, v200, v201
v_cvt_pk_bf16_f32 v121, v202, v203
ds_write_b64 v234, v[120:121] offset:35968
v_cvt_f32_i32 v204, v204
v_cvt_f32_i32 v205, v205
v_cvt_f32_i32 v206, v206
v_cvt_f32_i32 v207, v207
v_pk_fma_f32 v[204:205], v[204:205], v[96:97], v[100:101]
v_pk_fma_f32 v[206:207], v[206:207], v[98:99], v[102:103]
v_cvt_pk_bf16_f32 v122, v204, v205
v_cvt_pk_bf16_f32 v123, v206, v207
ds_write_b64 v234, v[122:123] offset:36512
s_waitcnt vmcnt(2)
buffer_load_dwordx4 v[176:179], v237, s[24:27], 0 offen offset:2048 nt
v_cvt_f32_i32 v208, v208
v_cvt_f32_i32 v209, v209
v_cvt_f32_i32 v210, v210
v_cvt_f32_i32 v211, v211
v_pk_fma_f32 v[208:209], v[208:209], v[96:97], v[100:101]
v_pk_fma_f32 v[210:211], v[210:211], v[98:99], v[102:103]
v_cvt_pk_bf16_f32 v124, v208, v209
v_cvt_pk_bf16_f32 v125, v210, v211
ds_write_b64 v234, v[124:125] offset:37056
v_cvt_f32_i32 v212, v212
v_cvt_f32_i32 v213, v213
v_cvt_f32_i32 v214, v214
v_cvt_f32_i32 v215, v215
v_pk_fma_f32 v[212:213], v[212:213], v[96:97], v[100:101]
v_pk_fma_f32 v[214:215], v[214:215], v[98:99], v[102:103]
v_cvt_pk_bf16_f32 v126, v212, v213
v_cvt_pk_bf16_f32 v127, v214, v215
ds_write_b64 v234, v[126:127] offset:37600
s_waitcnt vmcnt(2)
buffer_load_dwordx4 v[180:183], v237, s[24:27], 0 offen offset:3072 nt
v_add_u32 v237, 0x8000, v237
s_waitcnt lgkmcnt(0)
s_barrier
ds_read_b128 v[112:115], v232 offset:33792
ds_read_b128 v[116:119], v232 offset:33824
ds_read_b128 v[120:123], v232 offset:33856
ds_read_b128 v[124:127], v232 offset:33888
ds_read_b128 v[128:131], v232 offset:33920
ds_read_b128 v[132:135], v232 offset:33952
ds_read_b128 v[136:139], v232 offset:33984
ds_read_b128 v[140:143], v232 offset:34016
s_waitcnt vmcnt(2)
buffer_load_dwordx4 v[184:187], v236, s[24:27], 0 offen offset:0 nt
s_waitcnt lgkmcnt(7)
v_mfma_f32_32x32x16_bf16 v[96:111], v[112:115], v[64:67], 0
s_waitcnt lgkmcnt(6)
v_mfma_f32_32x32x16_bf16 v[96:111], v[116:119], v[68:71], v[96:111]
s_waitcnt lgkmcnt(5)
v_mfma_f32_32x32x16_bf16 v[96:111], v[120:123], v[72:75], v[96:111]
s_waitcnt lgkmcnt(4)
v_mfma_f32_32x32x16_bf16 v[96:111], v[124:127], v[76:79], v[96:111]
s_waitcnt lgkmcnt(3)
v_mfma_f32_32x32x16_bf16 v[96:111], v[128:131], v[80:83], v[96:111]
s_waitcnt lgkmcnt(2)
v_mfma_f32_32x32x16_bf16 v[96:111], v[132:135], v[84:87], v[96:111]
s_waitcnt lgkmcnt(1)
v_mfma_f32_32x32x16_bf16 v[96:111], v[136:139], v[88:91], v[96:111]
s_waitcnt lgkmcnt(0)
v_mfma_f32_32x32x16_bf16 v[96:111], v[140:143], v[92:95], v[96:111]
ds_read_b128 v[112:115], v233 offset:51200
ds_read_b128 v[116:119], v233 offset:52224
ds_read_b128 v[120:123], v233 offset:53248
ds_read_b128 v[124:127], v233 offset:54272
ds_read_b128 v[128:131], v233 offset:55296
ds_read_b128 v[132:135], v233 offset:56320
ds_read_b128 v[136:139], v233 offset:57344
ds_read_b128 v[140:143], v233 offset:58368
s_waitcnt vmcnt(2)
buffer_load_dwordx4 v[188:191], v236, s[24:27], 0 offen offset:1024 nt
s_nop 1
v_max3_f32 v224, v96, v97, v98
v_max3_f32 v225, v99, v100, v101
v_max3_f32 v226, v102, v103, v104
v_max3_f32 v227, v105, v106, v107
v_max3_f32 v224, v224, v108, v109
v_max3_f32 v225, v225, v110, v111
v_max3_f32 v224, v224, v226, v227
v_max_f32 v224, v224, v225
v_cmp_gt_f32 vcc, v224, v221
s_nop 1
s_cbranch_vccz L_nr2
v_max_f32 v224, v224, v216
v_mov_b32 v225, v224
s_nop 1
v_permlane32_swap_b32 v224, v225
s_nop 0
v_max_f32 v224, v224, v225
v_sub_f32 v226, v216, v224
v_mul_f32 v226, s40, v226
v_mul_f32 v220, s44, v224
v_exp_f32 v222, v226
v_mov_b32 v216, v224
v_add_f32 v221, s45, v224
v_pk_mul_f32 v[218:219], v[218:219], v[222:223] op_sel_hi:[1,0]
v_pk_mul_f32 v[0:1], v[0:1], v[222:223] op_sel_hi:[1,0]
v_pk_mul_f32 v[2:3], v[2:3], v[222:223] op_sel_hi:[1,0]
v_pk_mul_f32 v[4:5], v[4:5], v[222:223] op_sel_hi:[1,0]
v_pk_mul_f32 v[6:7], v[6:7], v[222:223] op_sel_hi:[1,0]
v_pk_mul_f32 v[8:9], v[8:9], v[222:223] op_sel_hi:[1,0]
v_pk_mul_f32 v[10:11], v[10:11], v[222:223] op_sel_hi:[1,0]
v_pk_mul_f32 v[12:13], v[12:13], v[222:223] op_sel_hi:[1,0]
v_pk_mul_f32 v[14:15], v[14:15], v[222:223] op_sel_hi:[1,0]
v_pk_mul_f32 v[16:17], v[16:17], v[222:223] op_sel_hi:[1,0]
v_pk_mul_f32 v[18:19], v[18:19], v[222:223] op_sel_hi:[1,0]
v_pk_mul_f32 v[20:21], v[20:21], v[222:223] op_sel_hi:[1,0]
v_pk_mul_f32 v[22:23], v[22:23], v[222:223] op_sel_hi:[1,0]
v_pk_mul_f32 v[24:25], v[24:25], v[222:223] op_sel_hi:[1,0]
v_pk_mul_f32 v[26:27], v[26:27], v[222:223] op_sel_hi:[1,0]
v_pk_mul_f32 v[28:29], v[28:29], v[222:223] op_sel_hi:[1,0]
v_pk_mul_f32 v[30:31], v[30:31], v[222:223] op_sel_hi:[1,0]
v_pk_mul_f32 v[32:33], v[32:33], v[222:223] op_sel_hi:[1,0]
v_pk_mul_f32 v[34:35], v[34:35], v[222:223] op_sel_hi:[1,0]
v_pk_mul_f32 v[36:37], v[36:37], v[222:223] op_sel_hi:[1,0]
v_pk_mul_f32 v[38:39], v[38:39], v[222:223] op_sel_hi:[1,0]
v_pk_mul_f32 v[40:41], v[40:41], v[222:223] op_sel_hi:[1,0]
v_pk_mul_f32 v[42:43], v[42:43], v[222:223] op_sel_hi:[1,0]
v_pk_mul_f32 v[44:45], v[44:45], v[222:223] op_sel_hi:[1,0]
v_pk_mul_f32 v[46:47], v[46:47], v[222:223] op_sel_hi:[1,0]
v_pk_mul_f32 v[48:49], v[48:49], v[222:223] op_sel_hi:[1,0]
v_pk_mul_f32 v[50:51], v[50:51], v[222:223] op_sel_hi:[1,0]
v_pk_mul_f32 v[52:53], v[52:53], v[222:223] op_sel_hi:[1,0]
v_pk_mul_f32 v[54:55], v[54:55], v[222:223] op_sel_hi:[1,0]
v_pk_mul_f32 v[56:57], v[56:57], v[222:223] op_sel_hi:[1,0]
v_pk_mul_f32 v[58:59], v[58:59], v[222:223] op_sel_hi:[1,0]
v_pk_mul_f32 v[60:61], v[60:61], v[222:223] op_sel_hi:[1,0]
v_pk_mul_f32 v[62:63], v[62:63], v[222:223] op_sel_hi:[1,0]
L_nr2:
v_pk_fma_f32 v[96:97], v[96:97], s[40:41], v[220:221] op_sel_hi:[1,1,0]
v_pk_fma_f32 v[98:99], v[98:99], s[40:41], v[220:221] op_sel_hi:[1,1,0]
v_pk_fma_f32 v[100:101], v[100:101], s[40:41], v[220:221] op_sel_hi:[1,1,0]
v_pk_fma_f32 v[102:103], v[102:103], s[40:41], v[220:221] op_sel_hi:[1,1,0]
v_pk_fma_f32 v[104:105], v[104:105], s[40:41], v[220:221] op_sel_hi:[1,1,0]
v_pk_fma_f32 v[106:107], v[106:107], s[40:41], v[220:221] op_sel_hi:[1,1,0]
v_pk_fma_f32 v[108:109], v[108:109], s[40:41], v[220:221] op_sel_hi:[1,1,0]
v_pk_fma_f32 v[110:111], v[110:111], s[40:41], v[220:221] op_sel_hi:[1,1,0]
v_exp_f32 v96, v96
v_exp_f32 v97, v97
v_exp_f32 v98, v98
v_exp_f32 v99, v99
v_exp_f32 v100, v100
v_exp_f32 v101, v101
v_exp_f32 v102, v102
v_exp_f32 v103, v103
v_exp_f32 v104, v104
v_exp_f32 v105, v105
v_exp_f32 v106, v106
v_exp_f32 v107, v107
v_exp_f32 v108, v108
v_exp_f32 v109, v109
v_exp_f32 v110, v110
v_exp_f32 v111, v111
s_waitcnt vmcnt(2)
buffer_load_dwordx4 v[192:195], v236, s[24:27], 0 offen offset:2048 nt
v_cvt_pk_bf16_f32 v144, v96, v97
v_cvt_pk_bf16_f32 v145, v98, v99
v_cvt_pk_bf16_f32 v146, v100, v101
v_cvt_pk_bf16_f32 v147, v102, v103
v_cvt_pk_bf16_f32 v148, v104, v105
v_cvt_pk_bf16_f32 v149, v106, v107
v_cvt_pk_bf16_f32 v150, v108, v109
v_cvt_pk_bf16_f32 v151, v110, v111
v_pk_add_f32 v[224:225], v[96:97], v[98:99]
v_pk_add_f32 v[226:227], v[100:101], v[102:103]
v_pk_add_f32 v[228:229], v[104:105], v[106:107]
v_pk_add_f32 v[230:231], v[108:109], v[110:111]
v_pk_add_f32 v[224:225], v[224:225], v[226:227]
v_pk_add_f32 v[228:229], v[228:229], v[230:231]
ds_read_b128 v[96:99], v235
ds_read_b128 v[100:103], v235 offset:512
v_add_u32 v235, 1024, v235
s_waitcnt vmcnt(2)
buffer_load_dwordx4 v[196:199], v236, s[24:27], 0 offen offset:3072 nt
v_add_u32 v236, 0x8000, v236
s_waitcnt lgkmcnt(2)
v_mfma_f32_32x32x16_bf16 v[0:15], v[112:115], v[144:147], v[0:15]
v_mfma_f32_32x32x16_bf16 v[16:31], v[116:119], v[144:147], v[16:31]
v_mfma_f32_32x32x16_bf16 v[32:47], v[120:123], v[144:147], v[32:47]
v_mfma_f32_32x32x16_bf16 v[48:63], v[124:127], v[144:147], v[48:63]
v_pk_add_f32 v[224:225], v[224:225], v[228:229]
v_pk_add_f32 v[218:219], v[218:219], v[224:225]
v_mfma_f32_32x32x16_bf16 v[0:15], v[128:131], v[148:151], v[0:15]
v_mfma_f32_32x32x16_bf16 v[16:31], v[132:135], v[148:151], v[16:31]
v_mfma_f32_32x32x16_bf16 v[32:47], v[136:139], v[148:151], v[32:47]
v_mfma_f32_32x32x16_bf16 v[48:63], v[140:143], v[148:151], v[48:63]
s_waitcnt vmcnt(2)
buffer_load_dwordx4 v[200:203], v237, s[24:27], 0 offen offset:0 nt
s_waitcnt vmcnt(5) lgkmcnt(0)
v_cvt_f32_i32 v152, v152
v_cvt_f32_i32 v153, v153
v_cvt_f32_i32 v154, v154
v_cvt_f32_i32 v155, v155
v_pk_fma_f32 v[152:153], v[152:153], v[96:97], v[100:101]
v_pk_fma_f32 v[154:155], v[154:155], v[98:99], v[102:103]
v_cvt_pk_bf16_f32 v112, v152, v153
v_cvt_pk_bf16_f32 v113, v154, v155
ds_write_b64 v234, v[112:113] offset:0
v_cvt_f32_i32 v156, v156
v_cvt_f32_i32 v157, v157
v_cvt_f32_i32 v158, v158
v_cvt_f32_i32 v159, v159
v_pk_fma_f32 v[156:157], v[156:157], v[96:97], v[100:101]
v_pk_fma_f32 v[158:159], v[158:159], v[98:99], v[102:103]
v_cvt_pk_bf16_f32 v114, v156, v157
v_cvt_pk_bf16_f32 v115, v158, v159
ds_write_b64 v234, v[114:115] offset:544
s_waitcnt vmcnt(2)
buffer_load_dwordx4 v[204:207], v237, s[24:27], 0 offen offset:1024 nt
v_cvt_f32_i32 v160, v160
v_cvt_f32_i32 v161, v161
v_cvt_f32_i32 v162, v162
v_cvt_f32_i32 v163, v163
v_pk_fma_f32 v[160:161], v[160:161], v[96:97], v[100:101]
v_pk_fma_f32 v[162:163], v[162:163], v[98:99], v[102:103]
v_cvt_pk_bf16_f32 v116, v160, v161
v_cvt_pk_bf16_f32 v117, v162, v163
ds_write_b64 v234, v[116:117] offset:1088
v_cvt_f32_i32 v164, v164
v_cvt_f32_i32 v165, v165
v_cvt_f32_i32 v166, v166
v_cvt_f32_i32 v167, v167
v_pk_fma_f32 v[164:165], v[164:165], v[96:97], v[100:101]
v_pk_fma_f32 v[166:167], v[166:167], v[98:99], v[102:103]
v_cvt_pk_bf16_f32 v118, v164, v165
v_cvt_pk_bf16_f32 v119, v166, v167
ds_write_b64 v234, v[118:119] offset:1632
v_cvt_f32_i32 v168, v168
v_cvt_f32_i32 v169, v169
v_cvt_f32_i32 v170, v170
v_cvt_f32_i32 v171, v171
v_pk_fma_f32 v[168:169], v[168:169], v[96:97], v[100:101]
v_pk_fma_f32 v[170:171], v[170:171], v[98:99], v[102:103]
v_cvt_pk_bf16_f32 v120, v168, v169
v_cvt_pk_bf16_f32 v121, v170, v171
ds_write_b64 v234, v[120:121] offset:2176
v_cvt_f32_i32 v172, v172
v_cvt_f32_i32 v173, v173
v_cvt_f32_i32 v174, v174
v_cvt_f32_i32 v175, v175
v_pk_fma_f32 v[172:173], v[172:173], v[96:97], v[100:101]
v_pk_fma_f32 v[174:175], v[174:175], v[98:99], v[102:103]
v_cvt_pk_bf16_f32 v122, v172, v173
v_cvt_pk_bf16_f32 v123, v174, v175
ds_write_b64 v234, v[122:123] offset:2720
s_waitcnt vmcnt(2)
buffer_load_dwordx4 v[208:211], v237, s[24:27], 0 offen offset:2048 nt
v_cvt_f32_i32 v176, v176
v_cvt_f32_i32 v177, v177
v_cvt_f32_i32 v178, v178
v_cvt_f32_i32 v179, v179
v_pk_fma_f32 v[176:177], v[176:177], v[96:97], v[100:101]
v_pk_fma_f32 v[178:179], v[178:179], v[98:99], v[102:103]
v_cvt_pk_bf16_f32 v124, v176, v177
v_cvt_pk_bf16_f32 v125, v178, v179
ds_write_b64 v234, v[124:125] offset:3264
v_cvt_f32_i32 v180, v180
v_cvt_f32_i32 v181, v181
v_cvt_f32_i32 v182, v182
v_cvt_f32_i32 v183, v183
v_pk_fma_f32 v[180:181], v[180:181], v[96:97], v[100:101]
v_pk_fma_f32 v[182:183], v[182:183], v[98:99], v[102:103]
v_cvt_pk_bf16_f32 v126, v180, v181
v_cvt_pk_bf16_f32 v127, v182, v183
ds_write_b64 v234, v[126:127] offset:3808
s_waitcnt vmcnt(2)
buffer_load_dwordx4 v[212:215], v237, s[24:27], 0 offen offset:3072 nt
v_add_u32 v237, 0x8000, v237
s_waitcnt lgkmcnt(0)
s_barrier
s_sub_u32 s42, s42, 1
s_cmp_lg_u32 s42, 0
s_cbranch_scc1 L_K_loop
ds_read_b128 v[112:115], v232 offset:0
ds_read_b128 v[116:119], v232 offset:32
ds_read_b128 v[120:123], v232 offset:64
ds_read_b128 v[124:127], v232 offset:96
ds_read_b128 v[128:131], v232 offset:128
ds_read_b128 v[132:135], v232 offset:160
ds_read_b128 v[136:139], v232 offset:192
ds_read_b128 v[140:143], v232 offset:224
s_waitcnt lgkmcnt(7)
v_mfma_f32_32x32x16_bf16 v[96:111], v[112:115], v[64:67], 0
s_waitcnt lgkmcnt(6)
v_mfma_f32_32x32x16_bf16 v[96:111], v[116:119], v[68:71], v[96:111]
s_waitcnt lgkmcnt(5)
v_mfma_f32_32x32x16_bf16 v[96:111], v[120:123], v[72:75], v[96:111]
s_waitcnt lgkmcnt(4)
v_mfma_f32_32x32x16_bf16 v[96:111], v[124:127], v[76:79], v[96:111]
s_waitcnt lgkmcnt(3)
v_mfma_f32_32x32x16_bf16 v[96:111], v[128:131], v[80:83], v[96:111]
s_waitcnt lgkmcnt(2)
v_mfma_f32_32x32x16_bf16 v[96:111], v[132:135], v[84:87], v[96:111]
s_waitcnt lgkmcnt(1)
v_mfma_f32_32x32x16_bf16 v[96:111], v[136:139], v[88:91], v[96:111]
s_waitcnt lgkmcnt(0)
v_mfma_f32_32x32x16_bf16 v[96:111], v[140:143], v[92:95], v[96:111]
ds_read_b128 v[112:115], v233 offset:17408
ds_read_b128 v[116:119], v233 offset:18432
ds_read_b128 v[120:123], v233 offset:19456
ds_read_b128 v[124:127], v233 offset:20480
ds_read_b128 v[128:131], v233 offset:21504
ds_read_b128 v[132:135], v233 offset:22528
ds_read_b128 v[136:139], v233 offset:23552
ds_read_b128 v[140:143], v233 offset:24576
s_nop 3
v_max3_f32 v224, v96, v97, v98
v_max3_f32 v225, v99, v100, v101
v_max3_f32 v226, v102, v103, v104
v_max3_f32 v227, v105, v106, v107
v_max3_f32 v224, v224, v108, v109
v_max3_f32 v225, v225, v110, v111
v_max3_f32 v224, v224, v226, v227
v_max_f32 v224, v224, v225
v_cmp_gt_f32 vcc, v224, v221
s_nop 1
s_cbranch_vccz L_nr3
v_max_f32 v224, v224, v216
v_mov_b32 v225, v224
s_nop 1
v_permlane32_swap_b32 v224, v225
s_nop 0
v_max_f32 v224, v224, v225
v_sub_f32 v226, v216, v224
v_mul_f32 v226, s40, v226
v_mul_f32 v220, s44, v224
v_exp_f32 v222, v226
v_mov_b32 v216, v224
v_add_f32 v221, s45, v224
v_pk_mul_f32 v[218:219], v[218:219], v[222:223] op_sel_hi:[1,0]
v_pk_mul_f32 v[0:1], v[0:1], v[222:223] op_sel_hi:[1,0]
v_pk_mul_f32 v[2:3], v[2:3], v[222:223] op_sel_hi:[1,0]
v_pk_mul_f32 v[4:5], v[4:5], v[222:223] op_sel_hi:[1,0]
v_pk_mul_f32 v[6:7], v[6:7], v[222:223] op_sel_hi:[1,0]
v_pk_mul_f32 v[8:9], v[8:9], v[222:223] op_sel_hi:[1,0]
v_pk_mul_f32 v[10:11], v[10:11], v[222:223] op_sel_hi:[1,0]
v_pk_mul_f32 v[12:13], v[12:13], v[222:223] op_sel_hi:[1,0]
v_pk_mul_f32 v[14:15], v[14:15], v[222:223] op_sel_hi:[1,0]
v_pk_mul_f32 v[16:17], v[16:17], v[222:223] op_sel_hi:[1,0]
v_pk_mul_f32 v[18:19], v[18:19], v[222:223] op_sel_hi:[1,0]
v_pk_mul_f32 v[20:21], v[20:21], v[222:223] op_sel_hi:[1,0]
v_pk_mul_f32 v[22:23], v[22:23], v[222:223] op_sel_hi:[1,0]
v_pk_mul_f32 v[24:25], v[24:25], v[222:223] op_sel_hi:[1,0]
v_pk_mul_f32 v[26:27], v[26:27], v[222:223] op_sel_hi:[1,0]
v_pk_mul_f32 v[28:29], v[28:29], v[222:223] op_sel_hi:[1,0]
v_pk_mul_f32 v[30:31], v[30:31], v[222:223] op_sel_hi:[1,0]
v_pk_mul_f32 v[32:33], v[32:33], v[222:223] op_sel_hi:[1,0]
v_pk_mul_f32 v[34:35], v[34:35], v[222:223] op_sel_hi:[1,0]
v_pk_mul_f32 v[36:37], v[36:37], v[222:223] op_sel_hi:[1,0]
v_pk_mul_f32 v[38:39], v[38:39], v[222:223] op_sel_hi:[1,0]
v_pk_mul_f32 v[40:41], v[40:41], v[222:223] op_sel_hi:[1,0]
v_pk_mul_f32 v[42:43], v[42:43], v[222:223] op_sel_hi:[1,0]
v_pk_mul_f32 v[44:45], v[44:45], v[222:223] op_sel_hi:[1,0]
v_pk_mul_f32 v[46:47], v[46:47], v[222:223] op_sel_hi:[1,0]
v_pk_mul_f32 v[48:49], v[48:49], v[222:223] op_sel_hi:[1,0]
v_pk_mul_f32 v[50:51], v[50:51], v[222:223] op_sel_hi:[1,0]
v_pk_mul_f32 v[52:53], v[52:53], v[222:223] op_sel_hi:[1,0]
v_pk_mul_f32 v[54:55], v[54:55], v[222:223] op_sel_hi:[1,0]
v_pk_mul_f32 v[56:57], v[56:57], v[222:223] op_sel_hi:[1,0]
v_pk_mul_f32 v[58:59], v[58:59], v[222:223] op_sel_hi:[1,0]
v_pk_mul_f32 v[60:61], v[60:61], v[222:223] op_sel_hi:[1,0]
v_pk_mul_f32 v[62:63], v[62:63], v[222:223] op_sel_hi:[1,0]
L_nr3:
v_pk_fma_f32 v[96:97], v[96:97], s[40:41], v[220:221] op_sel_hi:[1,1,0]
v_pk_fma_f32 v[98:99], v[98:99], s[40:41], v[220:221] op_sel_hi:[1,1,0]
v_pk_fma_f32 v[100:101], v[100:101], s[40:41], v[220:221] op_sel_hi:[1,1,0]
v_pk_fma_f32 v[102:103], v[102:103], s[40:41], v[220:221] op_sel_hi:[1,1,0]
v_pk_fma_f32 v[104:105], v[104:105], s[40:41], v[220:221] op_sel_hi:[1,1,0]
v_pk_fma_f32 v[106:107], v[106:107], s[40:41], v[220:221] op_sel_hi:[1,1,0]
v_pk_fma_f32 v[108:109], v[108:109], s[40:41], v[220:221] op_sel_hi:[1,1,0]
v_pk_fma_f32 v[110:111], v[110:111], s[40:41], v[220:221] op_sel_hi:[1,1,0]
v_exp_f32 v96, v96
v_exp_f32 v97, v97
v_exp_f32 v98, v98
v_exp_f32 v99, v99
v_exp_f32 v100, v100
v_exp_f32 v101, v101
v_exp_f32 v102, v102
v_exp_f32 v103, v103
v_exp_f32 v104, v104
v_exp_f32 v105, v105
v_exp_f32 v106, v106
v_exp_f32 v107, v107
v_exp_f32 v108, v108
v_exp_f32 v109, v109
v_exp_f32 v110, v110
v_exp_f32 v111, v111
v_cvt_pk_bf16_f32 v144, v96, v97
v_cvt_pk_bf16_f32 v145, v98, v99
v_cvt_pk_bf16_f32 v146, v100, v101
v_cvt_pk_bf16_f32 v147, v102, v103
v_cvt_pk_bf16_f32 v148, v104, v105
v_cvt_pk_bf16_f32 v149, v106, v107
v_cvt_pk_bf16_f32 v150, v108, v109
v_cvt_pk_bf16_f32 v151, v110, v111
v_pk_add_f32 v[224:225], v[96:97], v[98:99]
v_pk_add_f32 v[226:227], v[100:101], v[102:103]
v_pk_add_f32 v[228:229], v[104:105], v[106:107]
v_pk_add_f32 v[230:231], v[108:109], v[110:111]
v_pk_add_f32 v[224:225], v[224:225], v[226:227]
v_pk_add_f32 v[228:229], v[228:229], v[230:231]
ds_read_b128 v[96:99], v235
ds_read_b128 v[100:103], v235 offset:512
v_add_u32 v235, 1024, v235
s_waitcnt lgkmcnt(2)
v_mfma_f32_32x32x16_bf16 v[0:15], v[112:115], v[144:147], v[0:15]
v_mfma_f32_32x32x16_bf16 v[16:31], v[116:119], v[144:147], v[16:31]
v_mfma_f32_32x32x16_bf16 v[32:47], v[120:123], v[144:147], v[32:47]
v_mfma_f32_32x32x16_bf16 v[48:63], v[124:127], v[144:147], v[48:63]
v_pk_add_f32 v[224:225], v[224:225], v[228:229]
v_pk_add_f32 v[218:219], v[218:219], v[224:225]
v_mfma_f32_32x32x16_bf16 v[0:15], v[128:131], v[148:151], v[0:15]
v_mfma_f32_32x32x16_bf16 v[16:31], v[132:135], v[148:151], v[16:31]
v_mfma_f32_32x32x16_bf16 v[32:47], v[136:139], v[148:151], v[32:47]
v_mfma_f32_32x32x16_bf16 v[48:63], v[140:143], v[148:151], v[48:63]
s_waitcnt vmcnt(0) lgkmcnt(0)
v_cvt_f32_i32 v184, v184
v_cvt_f32_i32 v185, v185
v_cvt_f32_i32 v186, v186
v_cvt_f32_i32 v187, v187
v_pk_fma_f32 v[184:185], v[184:185], v[96:97], v[100:101]
v_pk_fma_f32 v[186:187], v[186:187], v[98:99], v[102:103]
v_cvt_pk_bf16_f32 v112, v184, v185
v_cvt_pk_bf16_f32 v113, v186, v187
ds_write_b64 v234, v[112:113] offset:33792
v_cvt_f32_i32 v188, v188
v_cvt_f32_i32 v189, v189
v_cvt_f32_i32 v190, v190
v_cvt_f32_i32 v191, v191
v_pk_fma_f32 v[188:189], v[188:189], v[96:97], v[100:101]
v_pk_fma_f32 v[190:191], v[190:191], v[98:99], v[102:103]
v_cvt_pk_bf16_f32 v114, v188, v189
v_cvt_pk_bf16_f32 v115, v190, v191
ds_write_b64 v234, v[114:115] offset:34336
v_cvt_f32_i32 v192, v192
v_cvt_f32_i32 v193, v193
v_cvt_f32_i32 v194, v194
v_cvt_f32_i32 v195, v195
v_pk_fma_f32 v[192:193], v[192:193], v[96:97], v[100:101]
v_pk_fma_f32 v[194:195], v[194:195], v[98:99], v[102:103]
v_cvt_pk_bf16_f32 v116, v192, v193
v_cvt_pk_bf16_f32 v117, v194, v195
ds_write_b64 v234, v[116:117] offset:34880
v_cvt_f32_i32 v196, v196
v_cvt_f32_i32 v197, v197
v_cvt_f32_i32 v198, v198
v_cvt_f32_i32 v199, v199
v_pk_fma_f32 v[196:197], v[196:197], v[96:97], v[100:101]
v_pk_fma_f32 v[198:199], v[198:199], v[98:99], v[102:103]
v_cvt_pk_bf16_f32 v118, v196, v197
v_cvt_pk_bf16_f32 v119, v198, v199
ds_write_b64 v234, v[118:119] offset:35424
v_cvt_f32_i32 v200, v200
v_cvt_f32_i32 v201, v201
v_cvt_f32_i32 v202, v202
v_cvt_f32_i32 v203, v203
v_pk_fma_f32 v[200:201], v[200:201], v[96:97], v[100:101]
v_pk_fma_f32 v[202:203], v[202:203], v[98:99], v[102:103]
v_cvt_pk_bf16_f32 v120, v200, v201
v_cvt_pk_bf16_f32 v121, v202, v203
ds_write_b64 v234, v[120:121] offset:35968
v_cvt_f32_i32 v204, v204
v_cvt_f32_i32 v205, v205
v_cvt_f32_i32 v206, v206
v_cvt_f32_i32 v207, v207
v_pk_fma_f32 v[204:205], v[204:205], v[96:97], v[100:101]
v_pk_fma_f32 v[206:207], v[206:207], v[98:99], v[102:103]
v_cvt_pk_bf16_f32 v122, v204, v205
v_cvt_pk_bf16_f32 v123, v206, v207
ds_write_b64 v234, v[122:123] offset:36512
v_cvt_f32_i32 v208, v208
v_cvt_f32_i32 v209, v209
v_cvt_f32_i32 v210, v210
v_cvt_f32_i32 v211, v211
v_pk_fma_f32 v[208:209], v[208:209], v[96:97], v[100:101]
v_pk_fma_f32 v[210:211], v[210:211], v[98:99], v[102:103]
v_cvt_pk_bf16_f32 v124, v208, v209
v_cvt_pk_bf16_f32 v125, v210, v211
ds_write_b64 v234, v[124:125] offset:37056
v_cvt_f32_i32 v212, v212
v_cvt_f32_i32 v213, v213
v_cvt_f32_i32 v214, v214
v_cvt_f32_i32 v215, v215
v_pk_fma_f32 v[212:213], v[212:213], v[96:97], v[100:101]
v_pk_fma_f32 v[214:215], v[214:215], v[98:99], v[102:103]
v_cvt_pk_bf16_f32 v126, v212, v213
v_cvt_pk_bf16_f32 v127, v214, v215
ds_write_b64 v234, v[126:127] offset:37600
s_waitcnt lgkmcnt(0)
s_barrier
s_cmp_lg_u32 s3, 0
s_cbranch_scc1 L_e0
global_load_dword v251, v252, s[62:63] sc1
L_e0:
ds_read_b128 v[112:115], v232 offset:33792
ds_read_b128 v[116:119], v232 offset:33824
ds_read_b128 v[120:123], v232 offset:33856
ds_read_b128 v[124:127], v232 offset:33888
ds_read_b128 v[128:131], v232 offset:33920
ds_read_b128 v[132:135], v232 offset:33952
ds_read_b128 v[136:139], v232 offset:33984
ds_read_b128 v[140:143], v232 offset:34016
s_waitcnt lgkmcnt(7)
v_mfma_f32_32x32x16_bf16 v[96:111], v[112:115], v[64:67], 0
s_waitcnt lgkmcnt(6)
v_mfma_f32_32x32x16_bf16 v[96:111], v[116:119], v[68:71], v[96:111]
s_waitcnt lgkmcnt(5)
v_mfma_f32_32x32x16_bf16 v[96:111], v[120:123], v[72:75], v[96:111]
s_waitcnt lgkmcnt(4)
v_mfma_f32_32x32x16_bf16 v[96:111], v[124:127], v[76:79], v[96:111]
s_waitcnt lgkmcnt(3)
v_mfma_f32_32x32x16_bf16 v[96:111], v[128:131], v[80:83], v[96:111]
s_waitcnt lgkmcnt(2)
v_mfma_f32_32x32x16_bf16 v[96:111], v[132:135], v[84:87], v[96:111]
s_waitcnt lgkmcnt(1)
v_mfma_f32_32x32x16_bf16 v[96:111], v[136:139], v[88:91], v[96:111]
s_waitcnt lgkmcnt(0)
v_mfma_f32_32x32x16_bf16 v[96:111], v[140:143], v[92:95], v[96:111]
ds_read_b128 v[112:115], v233 offset:51200
ds_read_b128 v[116:119], v233 offset:52224
ds_read_b128 v[120:123], v233 offset:53248
ds_read_b128 v[124:127], v233 offset:54272
ds_read_b128 v[128:131], v233 offset:55296
ds_read_b128 v[132:135], v233 offset:56320
ds_read_b128 v[136:139], v233 offset:57344
ds_read_b128 v[140:143], v233 offset:58368
s_nop 3
v_max3_f32 v224, v96, v97, v98
v_max3_f32 v225, v99, v100, v101
v_max3_f32 v226, v102, v103, v104
v_max3_f32 v227, v105, v106, v107
v_max3_f32 v224, v224, v108, v109
v_max3_f32 v225, v225, v110, v111
v_max3_f32 v224, v224, v226, v227
v_max_f32 v224, v224, v225
v_cmp_gt_f32 vcc, v224, v221
s_nop 1
s_cbranch_vccz L_nr4
v_max_f32 v224, v224, v216
v_mov_b32 v225, v224
s_nop 1
v_permlane32_swap_b32 v224, v225
s_nop 0
v_max_f32 v224, v224, v225
v_sub_f32 v226, v216, v224
v_mul_f32 v226, s40, v226
v_mul_f32 v220, s44, v224
v_exp_f32 v222, v226
v_mov_b32 v216, v224
v_add_f32 v221, s45, v224
v_pk_mul_f32 v[218:219], v[218:219], v[222:223] op_sel_hi:[1,0]
v_pk_mul_f32 v[0:1], v[0:1], v[222:223] op_sel_hi:[1,0]
v_pk_mul_f32 v[2:3], v[2:3], v[222:223] op_sel_hi:[1,0]
v_pk_mul_f32 v[4:5], v[4:5], v[222:223] op_sel_hi:[1,0]
v_pk_mul_f32 v[6:7], v[6:7], v[222:223] op_sel_hi:[1,0]
v_pk_mul_f32 v[8:9], v[8:9], v[222:223] op_sel_hi:[1,0]
v_pk_mul_f32 v[10:11], v[10:11], v[222:223] op_sel_hi:[1,0]
v_pk_mul_f32 v[12:13], v[12:13], v[222:223] op_sel_hi:[1,0]
v_pk_mul_f32 v[14:15], v[14:15], v[222:223] op_sel_hi:[1,0]
v_pk_mul_f32 v[16:17], v[16:17], v[222:223] op_sel_hi:[1,0]
v_pk_mul_f32 v[18:19], v[18:19], v[222:223] op_sel_hi:[1,0]
v_pk_mul_f32 v[20:21], v[20:21], v[222:223] op_sel_hi:[1,0]
v_pk_mul_f32 v[22:23], v[22:23], v[222:223] op_sel_hi:[1,0]
v_pk_mul_f32 v[24:25], v[24:25], v[222:223] op_sel_hi:[1,0]
v_pk_mul_f32 v[26:27], v[26:27], v[222:223] op_sel_hi:[1,0]
v_pk_mul_f32 v[28:29], v[28:29], v[222:223] op_sel_hi:[1,0]
v_pk_mul_f32 v[30:31], v[30:31], v[222:223] op_sel_hi:[1,0]
v_pk_mul_f32 v[32:33], v[32:33], v[222:223] op_sel_hi:[1,0]
v_pk_mul_f32 v[34:35], v[34:35], v[222:223] op_sel_hi:[1,0]
v_pk_mul_f32 v[36:37], v[36:37], v[222:223] op_sel_hi:[1,0]
v_pk_mul_f32 v[38:39], v[38:39], v[222:223] op_sel_hi:[1,0]
v_pk_mul_f32 v[40:41], v[40:41], v[222:223] op_sel_hi:[1,0]
v_pk_mul_f32 v[42:43], v[42:43], v[222:223] op_sel_hi:[1,0]
v_pk_mul_f32 v[44:45], v[44:45], v[222:223] op_sel_hi:[1,0]
v_pk_mul_f32 v[46:47], v[46:47], v[222:223] op_sel_hi:[1,0]
v_pk_mul_f32 v[48:49], v[48:49], v[222:223] op_sel_hi:[1,0]
v_pk_mul_f32 v[50:51], v[50:51], v[222:223] op_sel_hi:[1,0]
v_pk_mul_f32 v[52:53], v[52:53], v[222:223] op_sel_hi:[1,0]
v_pk_mul_f32 v[54:55], v[54:55], v[222:223] op_sel_hi:[1,0]
v_pk_mul_f32 v[56:57], v[56:57], v[222:223] op_sel_hi:[1,0]
v_pk_mul_f32 v[58:59], v[58:59], v[222:223] op_sel_hi:[1,0]
v_pk_mul_f32 v[60:61], v[60:61], v[222:223] op_sel_hi:[1,0]
v_pk_mul_f32 v[62:63], v[62:63], v[222:223] op_sel_hi:[1,0]
L_nr4:
v_pk_fma_f32 v[96:97], v[96:97], s[40:41], v[220:221] op_sel_hi:[1,1,0]
v_pk_fma_f32 v[98:99], v[98:99], s[40:41], v[220:221] op_sel_hi:[1,1,0]
v_pk_fma_f32 v[100:101], v[100:101], s[40:41], v[220:221] op_sel_hi:[1,1,0]
v_pk_fma_f32 v[102:103], v[102:103], s[40:41], v[220:221] op_sel_hi:[1,1,0]
v_pk_fma_f32 v[104:105], v[104:105], s[40:41], v[220:221] op_sel_hi:[1,1,0]
v_pk_fma_f32 v[106:107], v[106:107], s[40:41], v[220:221] op_sel_hi:[1,1,0]
v_pk_fma_f32 v[108:109], v[108:109], s[40:41], v[220:221] op_sel_hi:[1,1,0]
v_pk_fma_f32 v[110:111], v[110:111], s[40:41], v[220:221] op_sel_hi:[1,1,0]
v_exp_f32 v96, v96
v_exp_f32 v97, v97
v_exp_f32 v98, v98
v_exp_f32 v99, v99
v_exp_f32 v100, v100
v_exp_f32 v101, v101
v_exp_f32 v102, v102
v_exp_f32 v103, v103
v_exp_f32 v104, v104
v_exp_f32 v105, v105
v_exp_f32 v106, v106
v_exp_f32 v107, v107
v_exp_f32 v108, v108
v_exp_f32 v109, v109
v_exp_f32 v110, v110
v_exp_f32 v111, v111
v_cvt_pk_bf16_f32 v144, v96, v97
v_cvt_pk_bf16_f32 v145, v98, v99
v_cvt_pk_bf16_f32 v146, v100, v101
v_cvt_pk_bf16_f32 v147, v102, v103
v_cvt_pk_bf16_f32 v148, v104, v105
v_cvt_pk_bf16_f32 v149, v106, v107
v_cvt_pk_bf16_f32 v150, v108, v109
v_cvt_pk_bf16_f32 v151, v110, v111
v_pk_add_f32 v[224:225], v[96:97], v[98:99]
v_pk_add_f32 v[226:227], v[100:101], v[102:103]
v_pk_add_f32 v[228:229], v[104:105], v[106:107]
v_pk_add_f32 v[230:231], v[108:109], v[110:111]
v_pk_add_f32 v[224:225], v[224:225], v[226:227]
v_pk_add_f32 v[228:229], v[228:229], v[230:231]
s_waitcnt lgkmcnt(0)
v_mfma_f32_32x32x16_bf16 v[0:15], v[112:115], v[144:147], v[0:15]
v_mfma_f32_32x32x16_bf16 v[16:31], v[116:119], v[144:147], v[16:31]
v_mfma_f32_32x32x16_bf16 v[32:47], v[120:123], v[144:147], v[32:47]
v_mfma_f32_32x32x16_bf16 v[48:63], v[124:127], v[144:147], v[48:63]
v_pk_add_f32 v[224:225], v[224:225], v[228:229]
v_pk_add_f32 v[218:219], v[218:219], v[224:225]
v_mfma_f32_32x32x16_bf16 v[0:15], v[128:131], v[148:151], v[0:15]
v_mfma_f32_32x32x16_bf16 v[16:31], v[132:135], v[148:151], v[16:31]
v_mfma_f32_32x32x16_bf16 v[32:47], v[136:139], v[148:151], v[32:47]
v_mfma_f32_32x32x16_bf16 v[48:63], v[140:143], v[148:151], v[48:63]
v_add_f32 v217, v218, v219
v_mov_b32 v224, v217
s_nop 1
v_permlane32_swap_b32 v217, v224
s_nop 0
v_add_f32 v217, v217, v224
s_mul_i32 s56, s3, 8704
s_add_u32 s56, s56, 68608
s_xor_b32 s58, s3, 4
s_mul_i32 s57, s58, 8704
s_add_u32 s57, s57, 68608
v_lshlrev_b32 v225, 4, v238
v_add_u32 v226, s56, v225
v_add_u32 v227, s57, v225
v_lshlrev_b32 v225, 3, v238
v_add_u32 v228, s56, v225
v_add_u32 v229, s57, v225
s_lshl_b32 s56, s36, 5
s_add_u32 s56, s56, s3
s_mul_i32 s56, s56, 4608
s_add_u32 s28, s22, s56
s_addc_u32 s29, s23, 0
s_mov_b32 s30, 115200
s_mov_b32 s31, 0x20000
ds_write_b128 v226, v[8:11] offset:0
ds_write_b128 v226, v[12:15] offset:1024
ds_write_b128 v226, v[24:27] offset:2048
ds_write_b128 v226, v[28:31] offset:3072
ds_write_b128 v226, v[40:43] offset:4096
ds_write_b128 v226, v[44:47] offset:5120
ds_write_b128 v226, v[56:59] offset:6144
ds_write_b128 v226, v[60:63] offset:7168
ds_write_b64 v228, v[216:217] offset:8192
s_waitcnt vmcnt(0)
s_cmp_lg_u32 s3, 0
s_cbranch_scc1 L_e1
ds_write_b32 v250, v251
L_e1:
s_waitcnt lgkmcnt(0)
s_barrier
ds_read_b32 v243, v250
ds_read_b128 v[112:115], v227 offset:0
ds_read_b128 v[116:119], v227 offset:1024
ds_read_b128 v[120:123], v227 offset:2048
ds_read_b128 v[124:127], v227 offset:3072
ds_read_b128 v[128:131], v227 offset:4096
ds_read_b128 v[132:135], v227 offset:5120
ds_read_b128 v[136:139], v227 offset:6144
ds_read_b128 v[140:143], v227 offset:7168
ds_read_b64 v[246:247], v229 offset:8192
s_waitcnt lgkmcnt(9)
v_readfirstlane_b32 s58, v243
s_cmp_lt_u32 s58, 3
s_cbranch_scc1 L_K_nold
v_lshlrev_b32 v224, 4, v238
v_lshlrev_b32 v225, 3, v238
v_add_u32 v225, 4096, v225
s_add_u32 s56, s37, 1
s_and_b32 s56, s56, 3
s_mul_i32 s88, s56, 36864
v_add_u32 v244, s88, v225
buffer_load_dwordx2 v[144:145], v244, s[28:31], 0 offen sc1
s_add_u32 s56, s37, 2
s_and_b32 s56, s56, 3
s_mul_i32 s89, s56, 36864
v_add_u32 v244, s89, v225
buffer_load_dwordx2 v[146:147], v244, s[28:31], 0 offen sc1
s_add_u32 s56, s37, 3
s_and_b32 s56, s56, 3
s_mul_i32 s90, s56, 36864
v_add_u32 v244, s90, v225
buffer_load_dwordx2 v[148:149], v244, s[28:31], 0 offen sc1
v_add_u32 v242, s88, v224
buffer_load_dwordx4 v[152:155], v242, s[28:31], 0 offen offset:0 sc1
buffer_load_dwordx4 v[156:159], v242, s[28:31], 0 offen offset:1024 sc1
buffer_load_dwordx4 v[160:163], v242, s[28:31], 0 offen offset:2048 sc1
buffer_load_dwordx4 v[164:167], v242, s[28:31], 0 offen offset:3072 sc1
v_add_u32 v242, s89, v224
buffer_load_dwordx4 v[168:171], v242, s[28:31], 0 offen offset:0 sc1
buffer_load_dwordx4 v[172:175], v242, s[28:31], 0 offen offset:1024 sc1
buffer_load_dwordx4 v[176:179], v242, s[28:31], 0 offen offset:2048 sc1
buffer_load_dwordx4 v[180:183], v242, s[28:31], 0 offen offset:3072 sc1
v_add_u32 v242, s90, v224
buffer_load_dwordx4 v[184:187], v242, s[28:31], 0 offen offset:0 sc1
buffer_load_dwordx4 v[188:191], v242, s[28:31], 0 offen offset:1024 sc1
buffer_load_dwordx4 v[192:195], v242, s[28:31], 0 offen offset:2048 sc1
buffer_load_dwordx4 v[196:199], v242, s[28:31], 0 offen offset:3072 sc1
L_K_nold:
s_waitcnt lgkmcnt(0)
v_max_f32 v224, v216, v246
v_sub_f32 v226, v216, v224
v_sub_f32 v228, v246, v224
v_mul_f32 v226, s40, v226
v_mul_f32 v228, s40, v228
v_exp_f32 v226, v226
v_exp_f32 v228, v228
v_mov_b32 v216, v224
v_mul_f32 v217, v217, v226
v_fmac_f32 v217, v247, v228
v_pk_mul_f32 v[0:1], v[0:1], v[226:227] op_sel_hi:[1,0]
v_pk_fma_f32 v[0:1], v[112:113], v[228:229], v[0:1] op_sel_hi:[1,0,1]
v_pk_mul_f32 v[2:3], v[2:3], v[226:227] op_sel_hi:[1,0]
v_pk_fma_f32 v[2:3], v[114:115], v[228:229], v[2:3] op_sel_hi:[1,0,1]
v_pk_mul_f32 v[4:5], v[4:5], v[226:227] op_sel_hi:[1,0]
v_pk_fma_f32 v[4:5], v[116:117], v[228:229], v[4:5] op_sel_hi:[1,0,1]
v_pk_mul_f32 v[6:7], v[6:7], v[226:227] op_sel_hi:[1,0]
v_pk_fma_f32 v[6:7], v[118:119], v[228:229], v[6:7] op_sel_hi:[1,0,1]
v_pk_mul_f32 v[16:17], v[16:17], v[226:227] op_sel_hi:[1,0]
v_pk_fma_f32 v[16:17], v[120:121], v[228:229], v[16:17] op_sel_hi:[1,0,1]
v_pk_mul_f32 v[18:19], v[18:19], v[226:227] op_sel_hi:[1,0]
v_pk_fma_f32 v[18:19], v[122:123], v[228:229], v[18:19] op_sel_hi:[1,0,1]
v_pk_mul_f32 v[20:21], v[20:21], v[226:227] op_sel_hi:[1,0]
v_pk_fma_f32 v[20:21], v[124:125], v[228:229], v[20:21] op_sel_hi:[1,0,1]
v_pk_mul_f32 v[22:23], v[22:23], v[226:227] op_sel_hi:[1,0]
v_pk_fma_f32 v[22:23], v[126:127], v[228:229], v[22:23] op_sel_hi:[1,0,1]
v_pk_mul_f32 v[32:33], v[32:33], v[226:227] op_sel_hi:[1,0]
v_pk_fma_f32 v[32:33], v[128:129], v[228:229], v[32:33] op_sel_hi:[1,0,1]
v_pk_mul_f32 v[34:35], v[34:35], v[226:227] op_sel_hi:[1,0]
v_pk_fma_f32 v[34:35], v[130:131], v[228:229], v[34:35] op_sel_hi:[1,0,1]
v_pk_mul_f32 v[36:37], v[36:37], v[226:227] op_sel_hi:[1,0]
v_pk_fma_f32 v[36:37], v[132:133], v[228:229], v[36:37] op_sel_hi:[1,0,1]
v_pk_mul_f32 v[38:39], v[38:39], v[226:227] op_sel_hi:[1,0]
v_pk_fma_f32 v[38:39], v[134:135], v[228:229], v[38:39] op_sel_hi:[1,0,1]
v_pk_mul_f32 v[48:49], v[48:49], v[226:227] op_sel_hi:[1,0]
v_pk_fma_f32 v[48:49], v[136:137], v[228:229], v[48:49] op_sel_hi:[1,0,1]
v_pk_mul_f32 v[50:51], v[50:51], v[226:227] op_sel_hi:[1,0]
v_pk_fma_f32 v[50:51], v[138:139], v[228:229], v[50:51] op_sel_hi:[1,0,1]
v_pk_mul_f32 v[52:53], v[52:53], v[226:227] op_sel_hi:[1,0]
v_pk_fma_f32 v[52:53], v[140:141], v[228:229], v[52:53] op_sel_hi:[1,0,1]
v_pk_mul_f32 v[54:55], v[54:55], v[226:227] op_sel_hi:[1,0]
v_pk_fma_f32 v[54:55], v[142:143], v[228:229], v[54:55] op_sel_hi:[1,0,1]
s_cmp_ge_u32 s58, 3
s_cbranch_scc1 L_K_comb
s_mul_i32 s56, s37, 36864
v_lshlrev_b32 v224, 4, v238
v_add_u32 v224, s56, v224
v_lshlrev_b32 v226, 3, v238
v_add_u32 v226, s56, v226
v_add_u32 v226, 4096, v226
buffer_store_dwordx2 v[216:217], v226, s[28:31], 0 offen sc1
v_cvt_pk_bf16_f32 v112, v0, v1
v_cvt_pk_bf16_f32 v113, v2, v3
v_cvt_pk_bf16_f32 v114, v4, v5
v_cvt_pk_bf16_f32 v115, v6, v7
buffer_store_dwordx4 v[112:115], v224, s[28:31], 0 offen offset:0 sc1
v_cvt_pk_bf16_f32 v116, v16, v17
v_cvt_pk_bf16_f32 v117, v18, v19
v_cvt_pk_bf16_f32 v118, v20, v21
v_cvt_pk_bf16_f32 v119, v22, v23
buffer_store_dwordx4 v[116:119], v224, s[28:31], 0 offen offset:1024 sc1
v_cvt_pk_bf16_f32 v120, v32, v33
v_cvt_pk_bf16_f32 v121, v34, v35
v_cvt_pk_bf16_f32 v122, v36, v37
v_cvt_pk_bf16_f32 v123, v38, v39
buffer_store_dwordx4 v[120:123], v224, s[28:31], 0 offen offset:2048 sc1
v_cvt_pk_bf16_f32 v124, v48, v49
v_cvt_pk_bf16_f32 v125, v50, v51
v_cvt_pk_bf16_f32 v126, v52, v53
v_cvt_pk_bf16_f32 v127, v54, v55
buffer_store_dwordx4 v[124:127], v224, s[28:31], 0 offen offset:3072 sc1
s_waitcnt vmcnt(0)
s_barrier
s_cmp_lg_u32 s3, 0
s_cbranch_scc1 L_e2
s_mov_b64 exec, 1
v_mov_b32 v242, 1
global_atomic_add v243, v252, v242, s[62:63] sc0
s_waitcnt vmcnt(0)
ds_write_b32 v250, v243 offset:4
s_waitcnt lgkmcnt(0)
s_mov_b64 exec, -1
L_e2:
s_barrier
ds_read_b32 v243, v250 offset:4
s_waitcnt lgkmcnt(0)
v_readfirstlane_b32 s58, v243
s_cmp_ge_u32 s58, 3
s_cbranch_scc1 L_K_late
s_endpgm
L_K_late:
v_lshlrev_b32 v224, 4, v238
v_lshlrev_b32 v225, 3, v238
v_add_u32 v225, 4096, v225
s_add_u32 s56, s37, 1
s_and_b32 s56, s56, 3
s_mul_i32 s88, s56, 36864
v_add_u32 v244, s88, v225
buffer_load_dwordx2 v[144:145], v244, s[28:31], 0 offen sc1
s_add_u32 s56, s37, 2
s_and_b32 s56, s56, 3
s_mul_i32 s89, s56, 36864
v_add_u32 v244, s89, v225
buffer_load_dwordx2 v[146:147], v244, s[28:31], 0 offen sc1
s_add_u32 s56, s37, 3
s_and_b32 s56, s56, 3
s_mul_i32 s90, s56, 36864
v_add_u32 v244, s90, v225
buffer_load_dwordx2 v[148:149], v244, s[28:31], 0 offen sc1
v_add_u32 v242, s88, v224
buffer_load_dwordx4 v[152:155], v242, s[28:31], 0 offen offset:0 sc1
buffer_load_dwordx4 v[156:159], v242, s[28:31], 0 offen offset:1024 sc1
buffer_load_dwordx4 v[160:163], v242, s[28:31], 0 offen offset:2048 sc1
buffer_load_dwordx4 v[164:167], v242, s[28:31], 0 offen offset:3072 sc1
v_add_u32 v242, s89, v224
buffer_load_dwordx4 v[168:171], v242, s[28:31], 0 offen offset:0 sc1
buffer_load_dwordx4 v[172:175], v242, s[28:31], 0 offen offset:1024 sc1
buffer_load_dwordx4 v[176:179], v242, s[28:31], 0 offen offset:2048 sc1
buffer_load_dwordx4 v[180:183], v242, s[28:31], 0 offen offset:3072 sc1
v_add_u32 v242, s90, v224
buffer_load_dwordx4 v[184:187], v242, s[28:31], 0 offen offset:0 sc1
buffer_load_dwordx4 v[188:191], v242, s[28:31], 0 offen offset:1024 sc1
buffer_load_dwordx4 v[192:195], v242, s[28:31], 0 offen offset:2048 sc1
buffer_load_dwordx4 v[196:199], v242, s[28:31], 0 offen offset:3072 sc1
L_K_comb:
s_add_u32 s32, s18, s43
s_addc_u32 s33, s19, 0
s_mov_b32 s34, 32768
s_mov_b32 s35, 0x20000
s_lshl_b32 s56, s38, 13
v_lshlrev_b32 v239, 8, v240
v_lshl_add_u32 v239, v241, 5, v239
v_add_u32 v239, s56, v239
s_waitcnt vmcnt(12)
v_max3_f32 v224, v216, v144, v146
v_max_f32 v224, v224, v148
v_sub_f32 v242, v216, v224
v_sub_f32 v244, v144, v224
v_sub_f32 v246, v146, v224
v_sub_f32 v248, v148, v224
v_mul_f32 v242, s40, v242
v_mul_f32 v244, s40, v244
v_mul_f32 v246, s40, v246
v_mul_f32 v248, s40, v248
v_exp_f32 v242, v242
v_exp_f32 v244, v244
v_exp_f32 v246, v246
v_exp_f32 v248, v248
s_nop 0
v_mul_f32 v217, v217, v242
v_fmac_f32 v217, v145, v244
v_fmac_f32 v217, v147, v246
v_fmac_f32 v217, v149, v248
v_rcp_f32 v224, v217
s_nop 0
v_mul_f32 v242, v242, v224
v_mul_f32 v244, v244, v224
v_mul_f32 v246, v246, v224
v_mul_f32 v248, v248, v224
v_pk_mul_f32 v[0:1], v[0:1], v[242:243] op_sel_hi:[1,0]
v_pk_mul_f32 v[2:3], v[2:3], v[242:243] op_sel_hi:[1,0]
v_pk_mul_f32 v[4:5], v[4:5], v[242:243] op_sel_hi:[1,0]
v_pk_mul_f32 v[6:7], v[6:7], v[242:243] op_sel_hi:[1,0]
v_pk_mul_f32 v[16:17], v[16:17], v[242:243] op_sel_hi:[1,0]
v_pk_mul_f32 v[18:19], v[18:19], v[242:243] op_sel_hi:[1,0]
v_pk_mul_f32 v[20:21], v[20:21], v[242:243] op_sel_hi:[1,0]
v_pk_mul_f32 v[22:23], v[22:23], v[242:243] op_sel_hi:[1,0]
v_pk_mul_f32 v[32:33], v[32:33], v[242:243] op_sel_hi:[1,0]
v_pk_mul_f32 v[34:35], v[34:35], v[242:243] op_sel_hi:[1,0]
v_pk_mul_f32 v[36:37], v[36:37], v[242:243] op_sel_hi:[1,0]
v_pk_mul_f32 v[38:39], v[38:39], v[242:243] op_sel_hi:[1,0]
v_pk_mul_f32 v[48:49], v[48:49], v[242:243] op_sel_hi:[1,0]
v_pk_mul_f32 v[50:51], v[50:51], v[242:243] op_sel_hi:[1,0]
v_pk_mul_f32 v[52:53], v[52:53], v[242:243] op_sel_hi:[1,0]
v_pk_mul_f32 v[54:55], v[54:55], v[242:243] op_sel_hi:[1,0]
s_waitcnt vmcnt(8)
v_lshlrev_b32 v112, 16, v152
v_and_b32 v113, 0xffff0000, v152
v_lshlrev_b32 v114, 16, v153
v_and_b32 v115, 0xffff0000, v153
v_lshlrev_b32 v116, 16, v154
v_and_b32 v117, 0xffff0000, v154
v_lshlrev_b32 v118, 16, v155
v_and_b32 v119, 0xffff0000, v155
v_lshlrev_b32 v120, 16, v156
v_and_b32 v121, 0xffff0000, v156
v_lshlrev_b32 v122, 16, v157
v_and_b32 v123, 0xffff0000, v157
v_lshlrev_b32 v124, 16, v158
v_and_b32 v125, 0xffff0000, v158
v_lshlrev_b32 v126, 16, v159
v_and_b32 v127, 0xffff0000, v159
v_lshlrev_b32 v128, 16, v160
v_and_b32 v129, 0xffff0000, v160
v_lshlrev_b32 v130, 16, v161
v_and_b32 v131, 0xffff0000, v161
v_lshlrev_b32 v132, 16, v162
v_and_b32 v133, 0xffff0000, v162
v_lshlrev_b32 v134, 16, v163
v_and_b32 v135, 0xffff0000, v163
v_lshlrev_b32 v136, 16, v164
v_and_b32 v137, 0xffff0000, v164
v_lshlrev_b32 v138, 16, v165
v_and_b32 v139, 0xffff0000, v165
v_lshlrev_b32 v140, 16, v166
v_and_b32 v141, 0xffff0000, v166
v_lshlrev_b32 v142, 16, v167
v_and_b32 v143, 0xffff0000, v167
v_pk_fma_f32 v[0:1], v[112:113], v[244:245], v[0:1] op_sel_hi:[1,0,1]
v_pk_fma_f32 v[2:3], v[114:115], v[244:245], v[2:3] op_sel_hi:[1,0,1]
v_pk_fma_f32 v[4:5], v[116:117], v[244:245], v[4:5] op_sel_hi:[1,0,1]
v_pk_fma_f32 v[6:7], v[118:119], v[244:245], v[6:7] op_sel_hi:[1,0,1]
v_pk_fma_f32 v[16:17], v[120:121], v[244:245], v[16:17] op_sel_hi:[1,0,1]
v_pk_fma_f32 v[18:19], v[122:123], v[244:245], v[18:19] op_sel_hi:[1,0,1]
v_pk_fma_f32 v[20:21], v[124:125], v[244:245], v[20:21] op_sel_hi:[1,0,1]
v_pk_fma_f32 v[22:23], v[126:127], v[244:245], v[22:23] op_sel_hi:[1,0,1]
v_pk_fma_f32 v[32:33], v[128:129], v[244:245], v[32:33] op_sel_hi:[1,0,1]
v_pk_fma_f32 v[34:35], v[130:131], v[244:245], v[34:35] op_sel_hi:[1,0,1]
v_pk_fma_f32 v[36:37], v[132:133], v[244:245], v[36:37] op_sel_hi:[1,0,1]
v_pk_fma_f32 v[38:39], v[134:135], v[244:245], v[38:39] op_sel_hi:[1,0,1]
v_pk_fma_f32 v[48:49], v[136:137], v[244:245], v[48:49] op_sel_hi:[1,0,1]
v_pk_fma_f32 v[50:51], v[138:139], v[244:245], v[50:51] op_sel_hi:[1,0,1]
v_pk_fma_f32 v[52:53], v[140:141], v[244:245], v[52:53] op_sel_hi:[1,0,1]
v_pk_fma_f32 v[54:55], v[142:143], v[244:245], v[54:55] op_sel_hi:[1,0,1]
s_waitcnt vmcnt(4)
v_lshlrev_b32 v112, 16, v168
v_and_b32 v113, 0xffff0000, v168
v_lshlrev_b32 v114, 16, v169
v_and_b32 v115, 0xffff0000, v169
v_lshlrev_b32 v116, 16, v170
v_and_b32 v117, 0xffff0000, v170
v_lshlrev_b32 v118, 16, v171
v_and_b32 v119, 0xffff0000, v171
v_lshlrev_b32 v120, 16, v172
v_and_b32 v121, 0xffff0000, v172
v_lshlrev_b32 v122, 16, v173
v_and_b32 v123, 0xffff0000, v173
v_lshlrev_b32 v124, 16, v174
v_and_b32 v125, 0xffff0000, v174
v_lshlrev_b32 v126, 16, v175
v_and_b32 v127, 0xffff0000, v175
v_lshlrev_b32 v128, 16, v176
v_and_b32 v129, 0xffff0000, v176
v_lshlrev_b32 v130, 16, v177
v_and_b32 v131, 0xffff0000, v177
v_lshlrev_b32 v132, 16, v178
v_and_b32 v133, 0xffff0000, v178
v_lshlrev_b32 v134, 16, v179
v_and_b32 v135, 0xffff0000, v179
v_lshlrev_b32 v136, 16, v180
v_and_b32 v137, 0xffff0000, v180
v_lshlrev_b32 v138, 16, v181
v_and_b32 v139, 0xffff0000, v181
v_lshlrev_b32 v140, 16, v182
v_and_b32 v141, 0xffff0000, v182
v_lshlrev_b32 v142, 16, v183
v_and_b32 v143, 0xffff0000, v183
v_pk_fma_f32 v[0:1], v[112:113], v[246:247], v[0:1] op_sel_hi:[1,0,1]
v_pk_fma_f32 v[2:3], v[114:115], v[246:247], v[2:3] op_sel_hi:[1,0,1]
v_pk_fma_f32 v[4:5], v[116:117], v[246:247], v[4:5] op_sel_hi:[1,0,1]
v_pk_fma_f32 v[6:7], v[118:119], v[246:247], v[6:7] op_sel_hi:[1,0,1]
v_pk_fma_f32 v[16:17], v[120:121], v[246:247], v[16:17] op_sel_hi:[1,0,1]
v_pk_fma_f32 v[18:19], v[122:123], v[246:247], v[18:19] op_sel_hi:[1,0,1]
v_pk_fma_f32 v[20:21], v[124:125], v[246:247], v[20:21] op_sel_hi:[1,0,1]
v_pk_fma_f32 v[22:23], v[126:127], v[246:247], v[22:23] op_sel_hi:[1,0,1]
v_pk_fma_f32 v[32:33], v[128:129], v[246:247], v[32:33] op_sel_hi:[1,0,1]
v_pk_fma_f32 v[34:35], v[130:131], v[246:247], v[34:35] op_sel_hi:[1,0,1]
v_pk_fma_f32 v[36:37], v[132:133], v[246:247], v[36:37] op_sel_hi:[1,0,1]
v_pk_fma_f32 v[38:39], v[134:135], v[246:247], v[38:39] op_sel_hi:[1,0,1]
v_pk_fma_f32 v[48:49], v[136:137], v[246:247], v[48:49] op_sel_hi:[1,0,1]
v_pk_fma_f32 v[50:51], v[138:139], v[246:247], v[50:51] op_sel_hi:[1,0,1]
v_pk_fma_f32 v[52:53], v[140:141], v[246:247], v[52:53] op_sel_hi:[1,0,1]
v_pk_fma_f32 v[54:55], v[142:143], v[246:247], v[54:55] op_sel_hi:[1,0,1]
s_waitcnt vmcnt(0)
v_lshlrev_b32 v112, 16, v184
v_and_b32 v113, 0xffff0000, v184
v_lshlrev_b32 v114, 16, v185
v_and_b32 v115, 0xffff0000, v185
v_lshlrev_b32 v116, 16, v186
v_and_b32 v117, 0xffff0000, v186
v_lshlrev_b32 v118, 16, v187
v_and_b32 v119, 0xffff0000, v187
v_lshlrev_b32 v120, 16, v188
v_and_b32 v121, 0xffff0000, v188
v_lshlrev_b32 v122, 16, v189
v_and_b32 v123, 0xffff0000, v189
v_lshlrev_b32 v124, 16, v190
v_and_b32 v125, 0xffff0000, v190
v_lshlrev_b32 v126, 16, v191
v_and_b32 v127, 0xffff0000, v191
v_lshlrev_b32 v128, 16, v192
v_and_b32 v129, 0xffff0000, v192
v_lshlrev_b32 v130, 16, v193
v_and_b32 v131, 0xffff0000, v193
v_lshlrev_b32 v132, 16, v194
v_and_b32 v133, 0xffff0000, v194
v_lshlrev_b32 v134, 16, v195
v_and_b32 v135, 0xffff0000, v195
v_lshlrev_b32 v136, 16, v196
v_and_b32 v137, 0xffff0000, v196
v_lshlrev_b32 v138, 16, v197
v_and_b32 v139, 0xffff0000, v197
v_lshlrev_b32 v140, 16, v198
v_and_b32 v141, 0xffff0000, v198
v_lshlrev_b32 v142, 16, v199
v_and_b32 v143, 0xffff0000, v199
v_pk_fma_f32 v[0:1], v[112:113], v[248:249], v[0:1] op_sel_hi:[1,0,1]
v_pk_fma_f32 v[2:3], v[114:115], v[248:249], v[2:3] op_sel_hi:[1,0,1]
v_pk_fma_f32 v[4:5], v[116:117], v[248:249], v[4:5] op_sel_hi:[1,0,1]
v_pk_fma_f32 v[6:7], v[118:119], v[248:249], v[6:7] op_sel_hi:[1,0,1]
v_pk_fma_f32 v[16:17], v[120:121], v[248:249], v[16:17] op_sel_hi:[1,0,1]
v_pk_fma_f32 v[18:19], v[122:123], v[248:249], v[18:19] op_sel_hi:[1,0,1]
v_pk_fma_f32 v[20:21], v[124:125], v[248:249], v[20:21] op_sel_hi:[1,0,1]
v_pk_fma_f32 v[22:23], v[126:127], v[248:249], v[22:23] op_sel_hi:[1,0,1]
v_pk_fma_f32 v[32:33], v[128:129], v[248:249], v[32:33] op_sel_hi:[1,0,1]
v_pk_fma_f32 v[34:35], v[130:131], v[248:249], v[34:35] op_sel_hi:[1,0,1]
v_pk_fma_f32 v[36:37], v[132:133], v[248:249], v[36:37] op_sel_hi:[1,0,1]
v_pk_fma_f32 v[38:39], v[134:135], v[248:249], v[38:39] op_sel_hi:[1,0,1]
v_pk_fma_f32 v[48:49], v[136:137], v[248:249], v[48:49] op_sel_hi:[1,0,1]
v_pk_fma_f32 v[50:51], v[138:139], v[248:249], v[50:51] op_sel_hi:[1,0,1]
v_pk_fma_f32 v[52:53], v[140:141], v[248:249], v[52:53] op_sel_hi:[1,0,1]
v_pk_fma_f32 v[54:55], v[142:143], v[248:249], v[54:55] op_sel_hi:[1,0,1]
v_cvt_pk_bf16_f32 v96, v0, v16
v_cvt_pk_bf16_f32 v97, v32, v48
v_cvt_pk_bf16_f32 v98, v1, v17
v_cvt_pk_bf16_f32 v99, v33, v49
v_cvt_pk_bf16_f32 v100, v2, v18
v_cvt_pk_bf16_f32 v101, v34, v50
v_cvt_pk_bf16_f32 v102, v3, v19
v_cvt_pk_bf16_f32 v103, v35, v51
buffer_store_dwordx4 v[96:99], v239, s[32:35], 0 offen offset:0
buffer_store_dwordx4 v[100:103], v239, s[32:35], 0 offen offset:16
v_cvt_pk_bf16_f32 v104, v4, v20
v_cvt_pk_bf16_f32 v105, v36, v52
v_cvt_pk_bf16_f32 v106, v5, v21
v_cvt_pk_bf16_f32 v107, v37, v53
v_cvt_pk_bf16_f32 v108, v6, v22
v_cvt_pk_bf16_f32 v109, v38, v54
v_cvt_pk_bf16_f32 v110, v7, v23
v_cvt_pk_bf16_f32 v111, v39, v55
buffer_store_dwordx4 v[104:107], v239, s[32:35], 0 offen offset:64
buffer_store_dwordx4 v[108:111], v239, s[32:35], 0 offen offset:80
s_endpgm
L_V_entry:
buffer_load_dwordx4 v[152:155], v236, s[24:27], 0 offen offset:0 nt
buffer_load_dwordx4 v[156:159], v236, s[24:27], 0 offen offset:512 nt
buffer_load_dwordx4 v[160:163], v236, s[24:27], 0 offen offset:1024 nt
buffer_load_dwordx4 v[164:167], v236, s[24:27], 0 offen offset:1536 nt
v_add_u32 v236, 0x8000, v236
buffer_load_dwordx4 v[168:171], v237, s[24:27], 0 offen offset:0 nt
buffer_load_dwordx4 v[172:175], v237, s[24:27], 0 offen offset:512 nt
buffer_load_dwordx4 v[176:179], v237, s[24:27], 0 offen offset:1024 nt
buffer_load_dwordx4 v[180:183], v237, s[24:27], 0 offen offset:1536 nt
v_add_u32 v237, 0x8000, v237
s_lshl_b32 s43, s36, 15
s_lshl_b32 s56, s2, 13
s_lshl_b32 s57, s2, 12
s_add_u32 s28, s10, s56
s_addc_u32 s29, s11, 0
s_mov_b32 s30, 8192
s_mov_b32 s31, 0x20000
s_add_u32 s32, s12, s56
s_addc_u32 s33, s13, 0
s_mov_b32 s34, 8192
s_mov_b32 s35, 0x20000
s_add_u32 s84, s14, s57
s_addc_u32 s85, s15, 0
s_mov_b32 s86, 4096
s_mov_b32 s87, 0x20000
s_add_u32 s48, s16, s57
s_addc_u32 s49, s17, 0
s_mov_b32 s50, 4096
s_mov_b32 s51, 0x20000
s_add_u32 s52, s4, s43
s_addc_u32 s53, s5, 0
s_mov_b32 s54, 32768
s_mov_b32 s55, 0x20000
v_lshlrev_b32 v228, 4, v239
v_lshlrev_b32 v229, 3, v239
buffer_load_dwordx4 v[112:115], v228, s[28:31], 0 offen nt
buffer_load_dwordx4 v[116:119], v228, s[32:35], 0 offen nt
buffer_load_dwordx2 v[120:121], v229, s[84:87], 0 offen nt
buffer_load_dwordx2 v[122:123], v229, s[48:51], 0 offen nt
v_lshlrev_b32 v226, 4, v238
s_lshl_b32 s60, s3, 12
v_add_u32 v226, s60, v226
buffer_load_dwordx4 v[64:67], v226, s[52:55], 0 offen offset:0 nt
buffer_load_dwordx4 v[68:71], v226, s[52:55], 0 offen offset:1024 nt
buffer_load_dwordx4 v[72:75], v226, s[52:55], 0 offen offset:2048 nt
buffer_load_dwordx4 v[76:79], v226, s[52:55], 0 offen offset:3072 nt
buffer_load_dwordx4 v[184:187], v236, s[24:27], 0 offen offset:0 nt
buffer_load_dwordx4 v[188:191], v236, s[24:27], 0 offen offset:512 nt
buffer_load_dwordx4 v[192:195], v236, s[24:27], 0 offen offset:1024 nt
buffer_load_dwordx4 v[196:199], v236, s[24:27], 0 offen offset:1536 nt
v_add_u32 v236, 0x8000, v236
s_mov_b32 s40, 0x3e0293ee
s_mov_b32 s41, 0x3e0293ee
s_mov_b32 s44, 0xbe0293ee
s_mov_b32 s45, 0x427af233
s_lshl_b32 s56, s36, 2
s_add_u32 s62, s20, s56
s_addc_u32 s63, s21, 0
s_mov_b32 s42, 15
s_lshl_b32 s60, s39, 5
v_add_u32 v227, s60, v240
v_mul_lo_u32 v232, v227, s80
v_lshl_add_u32 v232, v241, 4, v232
s_lshl_b32 s60, s39, 13
v_lshlrev_b32 v233, 4, v238
v_add_u32 v233, s60, v233
s_lshl_b32 s60, s38, 12
v_lshlrev_b32 v234, 4, v238
v_add_u32 v234, s60, v234
s_lshl_b32 s60, s38, 7
s_add_u32 s60, s60, 101376
v_lshlrev_b32 v235, 5, v241
v_add_u32 v235, s60, v235
v_mov_b32 v0, 0
v_mov_b32 v1, 0
v_mov_b32 v2, 0
v_mov_b32 v3, 0
v_mov_b32 v4, 0
v_mov_b32 v5, 0
v_mov_b32 v6, 0
v_mov_b32 v7, 0
v_mov_b32 v8, 0
v_mov_b32 v9, 0
v_mov_b32 v10, 0
v_mov_b32 v11, 0
v_mov_b32 v12, 0
v_mov_b32 v13, 0
v_mov_b32 v14, 0
v_mov_b32 v15, 0
v_mov_b32 v16, 0
v_mov_b32 v17, 0
v_mov_b32 v18, 0
v_mov_b32 v19, 0
v_mov_b32 v20, 0
v_mov_b32 v21, 0
v_mov_b32 v22, 0
v_mov_b32 v23, 0
v_mov_b32 v24, 0
v_mov_b32 v25, 0
v_mov_b32 v26, 0
v_mov_b32 v27, 0
v_mov_b32 v28, 0
v_mov_b32 v29, 0
v_mov_b32 v30, 0
v_mov_b32 v31, 0
v_mov_b32 v32, 0
v_mov_b32 v33, 0
v_mov_b32 v34, 0
v_mov_b32 v35, 0
v_mov_b32 v36, 0
v_mov_b32 v37, 0
v_mov_b32 v38, 0
v_mov_b32 v39, 0
v_mov_b32 v40, 0
v_mov_b32 v41, 0
v_mov_b32 v42, 0
v_mov_b32 v43, 0
v_mov_b32 v44, 0
v_mov_b32 v45, 0
v_mov_b32 v46, 0
v_mov_b32 v47, 0
v_mov_b32 v48, 0
v_mov_b32 v49, 0
v_mov_b32 v50, 0
v_mov_b32 v51, 0
v_mov_b32 v52, 0
v_mov_b32 v53, 0
v_mov_b32 v54, 0
v_mov_b32 v55, 0
v_mov_b32 v56, 0
v_mov_b32 v57, 0
v_mov_b32 v58, 0
v_mov_b32 v59, 0
v_mov_b32 v60, 0
v_mov_b32 v61, 0
v_mov_b32 v62, 0
v_mov_b32 v63, 0
v_mov_b32 v216, 0xff61b1e6
v_mov_b32 v221, 0xff61b1e6
v_mov_b32 v220, 0
v_mov_b32 v218, 0
v_mov_b32 v219, 0
v_mov_b32 v250, 138240
v_mov_b32 v252, 0
v_lshrrev_b32 v224, 4, v239
v_and_b32 v225, 15, v239
v_lshlrev_b32 v242, 10, v224
v_lshl_add_u32 v242, v225, 5, v242
v_add_u32 v242, 68608, v242
v_lshlrev_b32 v243, 5, v239
v_add_u32 v243, 101376, v243
v_lshrrev_b32 v224, 4, v238
s_lshl_b32 s60, s3, 4
v_add_u32 v224, s60, v224
v_mul_lo_u32 v244, v224, s80
v_lshl_add_u32 v244, v225, 4, v244
v_add_u32 v244, 33792, v244
s_lshl_b32 s60, s38, 5
v_add_u32 v224, s60, v240
v_mul_lo_u32 v245, v224, s80
v_lshl_add_u32 v245, v241, 4, v245
v_add_u32 v245, 33792, v245
s_waitcnt vmcnt(4)
v_lshlrev_b32 v96, 16, v112
v_and_b32 v97, 0xffff0000, v112
v_lshlrev_b32 v226, 16, v116
v_and_b32 v227, 0xffff0000, v116
v_mul_f32 v104, -v226, v96
v_mul_f32 v105, -v227, v97
v_lshlrev_b32 v98, 16, v113
v_and_b32 v99, 0xffff0000, v113
v_lshlrev_b32 v226, 16, v117
v_and_b32 v227, 0xffff0000, v117
v_mul_f32 v106, -v226, v98
v_mul_f32 v107, -v227, v99
v_lshlrev_b32 v100, 16, v114
v_and_b32 v101, 0xffff0000, v114
v_lshlrev_b32 v226, 16, v118
v_and_b32 v227, 0xffff0000, v118
v_mul_f32 v108, -v226, v100
v_mul_f32 v109, -v227, v101
v_lshlrev_b32 v102, 16, v115
v_and_b32 v103, 0xffff0000, v115
v_lshlrev_b32 v226, 16, v119
v_and_b32 v227, 0xffff0000, v119
v_mul_f32 v110, -v226, v102
v_mul_f32 v111, -v227, v103
ds_write_b128 v242, v[96:99]
ds_write_b128 v242, v[100:103] offset:16
ds_write_b128 v242, v[104:107] offset:512
ds_write_b128 v242, v[108:111] offset:528
s_waitcnt vmcnt(2)
buffer_load_dwordx4 v[200:203], v237, s[24:27], 0 offen offset:0 nt
v_lshlrev_b32 v144, 16, v120
v_and_b32 v145, 0xffff0000, v120
v_lshlrev_b32 v226, 16, v122
v_and_b32 v227, 0xffff0000, v122
v_mul_f32 v148, -v226, v144
v_mul_f32 v149, -v227, v145
v_lshlrev_b32 v146, 16, v121
v_and_b32 v147, 0xffff0000, v121
v_lshlrev_b32 v226, 16, v123
v_and_b32 v227, 0xffff0000, v123
v_mul_f32 v150, -v226, v146
v_mul_f32 v151, -v227, v147
ds_write_b128 v243, v[144:147]
ds_write_b128 v243, v[148:151] offset:16
ds_write_b128 v244, v[64:67] offset:0
ds_write_b128 v244, v[68:71] offset:1088
ds_write_b128 v244, v[72:75] offset:2176
ds_write_b128 v244, v[76:79] offset:3264
s_waitcnt vmcnt(2)
buffer_load_dwordx4 v[204:207], v237, s[24:27], 0 offen offset:512 nt
s_waitcnt lgkmcnt(0)
s_barrier
ds_read_b128 v[64:67], v245 offset:0
ds_read_b128 v[68:71], v245 offset:32
ds_read_b128 v[72:75], v245 offset:64
ds_read_b128 v[76:79], v245 offset:96
ds_read_b128 v[80:83], v245 offset:128
ds_read_b128 v[84:87], v245 offset:160
ds_read_b128 v[88:91], v245 offset:192
ds_read_b128 v[92:95], v245 offset:224
ds_read_b128 v[96:99], v235
ds_read_b128 v[100:103], v235 offset:16
ds_read_b128 v[104:107], v235 offset:64
ds_read_b128 v[108:111], v235 offset:80
v_add_u32 v235, 512, v235
s_waitcnt vmcnt(6) lgkmcnt(0)
v_cvt_f32_i32 v152, v152
v_cvt_f32_i32 v153, v153
v_cvt_f32_i32 v154, v154
v_cvt_f32_i32 v155, v155
v_pk_fma_f32 v[152:153], v[152:153], v[96:97], v[100:101] op_sel:[0,0,0] op_sel_hi:[1,0,0]
v_pk_fma_f32 v[154:155], v[154:155], v[96:97], v[100:101] op_sel:[0,0,0] op_sel_hi:[1,0,0]
v_cvt_f32_i32 v156, v156
v_cvt_f32_i32 v157, v157
v_cvt_f32_i32 v158, v158
v_cvt_f32_i32 v159, v159
v_pk_fma_f32 v[156:157], v[156:157], v[96:97], v[100:101] op_sel:[0,1,1] op_sel_hi:[1,1,1]
v_pk_fma_f32 v[158:159], v[158:159], v[96:97], v[100:101] op_sel:[0,1,1] op_sel_hi:[1,1,1]
v_cvt_pk_bf16_f32 v112, v152, v156
v_cvt_pk_bf16_f32 v116, v153, v157
v_cvt_pk_bf16_f32 v120, v154, v158
v_cvt_pk_bf16_f32 v124, v155, v159
s_waitcnt vmcnt(2)
buffer_load_dwordx4 v[208:211], v237, s[24:27], 0 offen offset:1024 nt
v_cvt_f32_i32 v160, v160
v_cvt_f32_i32 v161, v161
v_cvt_f32_i32 v162, v162
v_cvt_f32_i32 v163, v163
v_pk_fma_f32 v[160:161], v[160:161], v[98:99], v[102:103] op_sel:[0,0,0] op_sel_hi:[1,0,0]
v_pk_fma_f32 v[162:163], v[162:163], v[98:99], v[102:103] op_sel:[0,0,0] op_sel_hi:[1,0,0]
v_cvt_f32_i32 v164, v164
v_cvt_f32_i32 v165, v165
v_cvt_f32_i32 v166, v166
v_cvt_f32_i32 v167, v167
v_pk_fma_f32 v[164:165], v[164:165], v[98:99], v[102:103] op_sel:[0,1,1] op_sel_hi:[1,1,1]
v_pk_fma_f32 v[166:167], v[166:167], v[98:99], v[102:103] op_sel:[0,1,1] op_sel_hi:[1,1,1]
v_cvt_pk_bf16_f32 v113, v160, v164
v_cvt_pk_bf16_f32 v117, v161, v165
v_cvt_pk_bf16_f32 v121, v162, v166
v_cvt_pk_bf16_f32 v125, v163, v167
v_cvt_f32_i32 v168, v168
v_cvt_f32_i32 v169, v169
v_cvt_f32_i32 v170, v170
v_cvt_f32_i32 v171, v171
v_pk_fma_f32 v[168:169], v[168:169], v[104:105], v[108:109] op_sel:[0,0,0] op_sel_hi:[1,0,0]
v_pk_fma_f32 v[170:171], v[170:171], v[104:105], v[108:109] op_sel:[0,0,0] op_sel_hi:[1,0,0]
v_cvt_f32_i32 v172, v172
v_cvt_f32_i32 v173, v173
v_cvt_f32_i32 v174, v174
v_cvt_f32_i32 v175, v175
v_pk_fma_f32 v[172:173], v[172:173], v[104:105], v[108:109] op_sel:[0,1,1] op_sel_hi:[1,1,1]
v_pk_fma_f32 v[174:175], v[174:175], v[104:105], v[108:109] op_sel:[0,1,1] op_sel_hi:[1,1,1]
v_cvt_pk_bf16_f32 v114, v168, v172
v_cvt_pk_bf16_f32 v118, v169, v173
v_cvt_pk_bf16_f32 v122, v170, v174
v_cvt_pk_bf16_f32 v126, v171, v175
s_waitcnt vmcnt(2)
buffer_load_dwordx4 v[212:215], v237, s[24:27], 0 offen offset:1536 nt
v_add_u32 v237, 0x8000, v237
v_cvt_f32_i32 v176, v176
v_cvt_f32_i32 v177, v177
v_cvt_f32_i32 v178, v178
v_cvt_f32_i32 v179, v179
v_pk_fma_f32 v[176:177], v[176:177], v[106:107], v[110:111] op_sel:[0,0,0] op_sel_hi:[1,0,0]
v_pk_fma_f32 v[178:179], v[178:179], v[106:107], v[110:111] op_sel:[0,0,0] op_sel_hi:[1,0,0]
v_cvt_f32_i32 v180, v180
v_cvt_f32_i32 v181, v181
v_cvt_f32_i32 v182, v182
v_cvt_f32_i32 v183, v183
v_pk_fma_f32 v[180:181], v[180:181], v[106:107], v[110:111] op_sel:[0,1,1] op_sel_hi:[1,1,1]
v_pk_fma_f32 v[182:183], v[182:183], v[106:107], v[110:111] op_sel:[0,1,1] op_sel_hi:[1,1,1]
v_cvt_pk_bf16_f32 v115, v176, v180
v_cvt_pk_bf16_f32 v119, v177, v181
v_cvt_pk_bf16_f32 v123, v178, v182
v_cvt_pk_bf16_f32 v127, v179, v183
ds_write_b128 v234, v[112:115] offset:17408
ds_write_b128 v234, v[116:119] offset:18432
ds_write_b128 v234, v[120:123] offset:19456
ds_write_b128 v234, v[124:127] offset:20480
ds_read_b128 v[96:99], v235
ds_read_b128 v[100:103], v235 offset:16
ds_read_b128 v[104:107], v235 offset:64
ds_read_b128 v[108:111], v235 offset:80
v_add_u32 v235, 512, v235
s_waitcnt vmcnt(2)
buffer_load_dwordx4 v[152:155], v236, s[24:27], 0 offen offset:0 nt
s_waitcnt vmcnt(2)
buffer_load_dwordx4 v[156:159], v236, s[24:27], 0 offen offset:512 nt
s_waitcnt vmcnt(2)
buffer_load_dwordx4 v[160:163], v236, s[24:27], 0 offen offset:1024 nt
s_waitcnt vmcnt(2)
buffer_load_dwordx4 v[164:167], v236, s[24:27], 0 offen offset:1536 nt
v_add_u32 v236, 0x8000, v236
s_waitcnt lgkmcnt(0)
s_barrier
L_V_loop:
s_waitcnt vmcnt(4) lgkmcnt(0)
s_waitcnt vmcnt(2)
buffer_load_dwordx4 v[168:171], v237, s[24:27], 0 offen offset:0 nt
v_cvt_f32_i32 v184, v184
v_cvt_f32_i32 v185, v185
v_cvt_f32_i32 v186, v186
v_cvt_f32_i32 v187, v187
v_pk_fma_f32 v[184:185], v[184:185], v[96:97], v[100:101] op_sel:[0,0,0] op_sel_hi:[1,0,0]
v_pk_fma_f32 v[186:187], v[186:187], v[96:97], v[100:101] op_sel:[0,0,0] op_sel_hi:[1,0,0]
v_cvt_f32_i32 v188, v188
v_cvt_f32_i32 v189, v189
v_cvt_f32_i32 v190, v190
v_cvt_f32_i32 v191, v191
v_pk_fma_f32 v[188:189], v[188:189], v[96:97], v[100:101] op_sel:[0,1,1] op_sel_hi:[1,1,1]
v_pk_fma_f32 v[190:191], v[190:191], v[96:97], v[100:101] op_sel:[0,1,1] op_sel_hi:[1,1,1]
v_cvt_pk_bf16_f32 v112, v184, v188
v_cvt_pk_bf16_f32 v116, v185, v189
v_cvt_pk_bf16_f32 v120, v186, v190
v_cvt_pk_bf16_f32 v124, v187, v191
v_cvt_f32_i32 v192, v192
v_cvt_f32_i32 v193, v193
v_cvt_f32_i32 v194, v194
v_cvt_f32_i32 v195, v195
v_pk_fma_f32 v[192:193], v[192:193], v[98:99], v[102:103] op_sel:[0,0,0] op_sel_hi:[1,0,0]
v_pk_fma_f32 v[194:195], v[194:195], v[98:99], v[102:103] op_sel:[0,0,0] op_sel_hi:[1,0,0]
v_cvt_f32_i32 v196, v196
v_cvt_f32_i32 v197, v197
v_cvt_f32_i32 v198, v198
v_cvt_f32_i32 v199, v199
v_pk_fma_f32 v[196:197], v[196:197], v[98:99], v[102:103] op_sel:[0,1,1] op_sel_hi:[1,1,1]
v_pk_fma_f32 v[198:199], v[198:199], v[98:99], v[102:103] op_sel:[0,1,1] op_sel_hi:[1,1,1]
v_cvt_pk_bf16_f32 v113, v192, v196
v_cvt_pk_bf16_f32 v117, v193, v197
v_cvt_pk_bf16_f32 v121, v194, v198
v_cvt_pk_bf16_f32 v125, v195, v199
s_waitcnt vmcnt(2)
buffer_load_dwordx4 v[172:175], v237, s[24:27], 0 offen offset:512 nt
v_cvt_f32_i32 v200, v200
v_cvt_f32_i32 v201, v201
v_cvt_f32_i32 v202, v202
v_cvt_f32_i32 v203, v203
v_pk_fma_f32 v[200:201], v[200:201], v[104:105], v[108:109] op_sel:[0,0,0] op_sel_hi:[1,0,0]
v_pk_fma_f32 v[202:203], v[202:203], v[104:105], v[108:109] op_sel:[0,0,0] op_sel_hi:[1,0,0]
v_cvt_f32_i32 v204, v204
v_cvt_f32_i32 v205, v205
v_cvt_f32_i32 v206, v206
v_cvt_f32_i32 v207, v207
v_pk_fma_f32 v[204:205], v[204:205], v[104:105], v[108:109] op_sel:[0,1,1] op_sel_hi:[1,1,1]
v_pk_fma_f32 v[206:207], v[206:207], v[104:105], v[108:109] op_sel:[0,1,1] op_sel_hi:[1,1,1]
v_cvt_pk_bf16_f32 v114, v200, v204
v_cvt_pk_bf16_f32 v118, v201, v205
v_cvt_pk_bf16_f32 v122, v202, v206
v_cvt_pk_bf16_f32 v126, v203, v207
v_cvt_f32_i32 v208, v208
v_cvt_f32_i32 v209, v209
v_cvt_f32_i32 v210, v210
v_cvt_f32_i32 v211, v211
v_pk_fma_f32 v[208:209], v[208:209], v[106:107], v[110:111] op_sel:[0,0,0] op_sel_hi:[1,0,0]
v_pk_fma_f32 v[210:211], v[210:211], v[106:107], v[110:111] op_sel:[0,0,0] op_sel_hi:[1,0,0]
v_cvt_f32_i32 v212, v212
v_cvt_f32_i32 v213, v213
v_cvt_f32_i32 v214, v214
v_cvt_f32_i32 v215, v215
v_pk_fma_f32 v[212:213], v[212:213], v[106:107], v[110:111] op_sel:[0,1,1] op_sel_hi:[1,1,1]
v_pk_fma_f32 v[214:215], v[214:215], v[106:107], v[110:111] op_sel:[0,1,1] op_sel_hi:[1,1,1]
v_cvt_pk_bf16_f32 v115, v208, v212
v_cvt_pk_bf16_f32 v119, v209, v213
v_cvt_pk_bf16_f32 v123, v210, v214
v_cvt_pk_bf16_f32 v127, v211, v215
ds_write_b128 v234, v[112:115] offset:51200
ds_write_b128 v234, v[116:119] offset:52224
ds_write_b128 v234, v[120:123] offset:53248
ds_write_b128 v234, v[124:127] offset:54272
s_waitcnt vmcnt(2)
buffer_load_dwordx4 v[176:179], v237, s[24:27], 0 offen offset:1024 nt
ds_read_b128 v[112:115], v232 offset:0
ds_read_b128 v[116:119], v232 offset:32
ds_read_b128 v[120:123], v232 offset:64
ds_read_b128 v[124:127], v232 offset:96
ds_read_b128 v[128:131], v232 offset:128
ds_read_b128 v[132:135], v232 offset:160
ds_read_b128 v[136:139], v232 offset:192
ds_read_b128 v[140:143], v232 offset:224
s_waitcnt vmcnt(2)
buffer_load_dwordx4 v[180:183], v237, s[24:27], 0 offen offset:1536 nt
v_add_u32 v237, 0x8000, v237
s_waitcnt lgkmcnt(7)
v_mfma_f32_32x32x16_bf16 v[96:111], v[112:115], v[64:67], 0
s_waitcnt lgkmcnt(6)
v_mfma_f32_32x32x16_bf16 v[96:111], v[116:119], v[68:71], v[96:111]
s_waitcnt lgkmcnt(5)
v_mfma_f32_32x32x16_bf16 v[96:111], v[120:123], v[72:75], v[96:111]
s_waitcnt lgkmcnt(4)
v_mfma_f32_32x32x16_bf16 v[96:111], v[124:127], v[76:79], v[96:111]
s_waitcnt lgkmcnt(3)
v_mfma_f32_32x32x16_bf16 v[96:111], v[128:131], v[80:83], v[96:111]
s_waitcnt lgkmcnt(2)
v_mfma_f32_32x32x16_bf16 v[96:111], v[132:135], v[84:87], v[96:111]
s_waitcnt lgkmcnt(1)
v_mfma_f32_32x32x16_bf16 v[96:111], v[136:139], v[88:91], v[96:111]
s_waitcnt lgkmcnt(0)
v_mfma_f32_32x32x16_bf16 v[96:111], v[140:143], v[92:95], v[96:111]
ds_read_b128 v[112:115], v233 offset:17408
ds_read_b128 v[116:119], v233 offset:18432
ds_read_b128 v[120:123], v233 offset:19456
ds_read_b128 v[124:127], v233 offset:20480
ds_read_b128 v[128:131], v233 offset:21504
ds_read_b128 v[132:135], v233 offset:22528
ds_read_b128 v[136:139], v233 offset:23552
ds_read_b128 v[140:143], v233 offset:24576
s_waitcnt vmcnt(2)
buffer_load_dwordx4 v[184:187], v236, s[24:27], 0 offen offset:0 nt
s_nop 1
v_max3_f32 v224, v96, v97, v98
v_max3_f32 v225, v99, v100, v101
v_max3_f32 v226, v102, v103, v104
v_max3_f32 v227, v105, v106, v107
v_max3_f32 v224, v224, v108, v109
v_max3_f32 v225, v225, v110, v111
v_max3_f32 v224, v224, v226, v227
v_max_f32 v224, v224, v225
v_cmp_gt_f32 vcc, v224, v221
s_nop 1
s_cbranch_vccz L_nr5
v_max_f32 v224, v224, v216
v_mov_b32 v225, v224
s_nop 1
v_permlane32_swap_b32 v224, v225
s_nop 0
v_max_f32 v224, v224, v225
v_sub_f32 v226, v216, v224
v_mul_f32 v226, s40, v226
v_mul_f32 v220, s44, v224
v_exp_f32 v222, v226
v_mov_b32 v216, v224
v_add_f32 v221, s45, v224
v_pk_mul_f32 v[218:219], v[218:219], v[222:223] op_sel_hi:[1,0]
v_pk_mul_f32 v[0:1], v[0:1], v[222:223] op_sel_hi:[1,0]
v_pk_mul_f32 v[2:3], v[2:3], v[222:223] op_sel_hi:[1,0]
v_pk_mul_f32 v[4:5], v[4:5], v[222:223] op_sel_hi:[1,0]
v_pk_mul_f32 v[6:7], v[6:7], v[222:223] op_sel_hi:[1,0]
v_pk_mul_f32 v[8:9], v[8:9], v[222:223] op_sel_hi:[1,0]
v_pk_mul_f32 v[10:11], v[10:11], v[222:223] op_sel_hi:[1,0]
v_pk_mul_f32 v[12:13], v[12:13], v[222:223] op_sel_hi:[1,0]
v_pk_mul_f32 v[14:15], v[14:15], v[222:223] op_sel_hi:[1,0]
v_pk_mul_f32 v[16:17], v[16:17], v[222:223] op_sel_hi:[1,0]
v_pk_mul_f32 v[18:19], v[18:19], v[222:223] op_sel_hi:[1,0]
v_pk_mul_f32 v[20:21], v[20:21], v[222:223] op_sel_hi:[1,0]
v_pk_mul_f32 v[22:23], v[22:23], v[222:223] op_sel_hi:[1,0]
v_pk_mul_f32 v[24:25], v[24:25], v[222:223] op_sel_hi:[1,0]
v_pk_mul_f32 v[26:27], v[26:27], v[222:223] op_sel_hi:[1,0]
v_pk_mul_f32 v[28:29], v[28:29], v[222:223] op_sel_hi:[1,0]
v_pk_mul_f32 v[30:31], v[30:31], v[222:223] op_sel_hi:[1,0]
v_pk_mul_f32 v[32:33], v[32:33], v[222:223] op_sel_hi:[1,0]
v_pk_mul_f32 v[34:35], v[34:35], v[222:223] op_sel_hi:[1,0]
v_pk_mul_f32 v[36:37], v[36:37], v[222:223] op_sel_hi:[1,0]
v_pk_mul_f32 v[38:39], v[38:39], v[222:223] op_sel_hi:[1,0]
v_pk_mul_f32 v[40:41], v[40:41], v[222:223] op_sel_hi:[1,0]
v_pk_mul_f32 v[42:43], v[42:43], v[222:223] op_sel_hi:[1,0]
v_pk_mul_f32 v[44:45], v[44:45], v[222:223] op_sel_hi:[1,0]
v_pk_mul_f32 v[46:47], v[46:47], v[222:223] op_sel_hi:[1,0]
v_pk_mul_f32 v[48:49], v[48:49], v[222:223] op_sel_hi:[1,0]
v_pk_mul_f32 v[50:51], v[50:51], v[222:223] op_sel_hi:[1,0]
v_pk_mul_f32 v[52:53], v[52:53], v[222:223] op_sel_hi:[1,0]
v_pk_mul_f32 v[54:55], v[54:55], v[222:223] op_sel_hi:[1,0]
v_pk_mul_f32 v[56:57], v[56:57], v[222:223] op_sel_hi:[1,0]
v_pk_mul_f32 v[58:59], v[58:59], v[222:223] op_sel_hi:[1,0]
v_pk_mul_f32 v[60:61], v[60:61], v[222:223] op_sel_hi:[1,0]
v_pk_mul_f32 v[62:63], v[62:63], v[222:223] op_sel_hi:[1,0]
L_nr5:
v_pk_fma_f32 v[96:97], v[96:97], s[40:41], v[220:221] op_sel_hi:[1,1,0]
v_pk_fma_f32 v[98:99], v[98:99], s[40:41], v[220:221] op_sel_hi:[1,1,0]
v_pk_fma_f32 v[100:101], v[100:101], s[40:41], v[220:221] op_sel_hi:[1,1,0]
v_pk_fma_f32 v[102:103], v[102:103], s[40:41], v[220:221] op_sel_hi:[1,1,0]
v_pk_fma_f32 v[104:105], v[104:105], s[40:41], v[220:221] op_sel_hi:[1,1,0]
v_pk_fma_f32 v[106:107], v[106:107], s[40:41], v[220:221] op_sel_hi:[1,1,0]
v_pk_fma_f32 v[108:109], v[108:109], s[40:41], v[220:221] op_sel_hi:[1,1,0]
v_pk_fma_f32 v[110:111], v[110:111], s[40:41], v[220:221] op_sel_hi:[1,1,0]
v_exp_f32 v96, v96
v_exp_f32 v97, v97
v_exp_f32 v98, v98
v_exp_f32 v99, v99
v_exp_f32 v100, v100
v_exp_f32 v101, v101
v_exp_f32 v102, v102
v_exp_f32 v103, v103
v_exp_f32 v104, v104
v_exp_f32 v105, v105
v_exp_f32 v106, v106
v_exp_f32 v107, v107
v_exp_f32 v108, v108
v_exp_f32 v109, v109
v_exp_f32 v110, v110
v_exp_f32 v111, v111
s_waitcnt vmcnt(2)
buffer_load_dwordx4 v[188:191], v236, s[24:27], 0 offen offset:512 nt
v_cvt_pk_bf16_f32 v144, v96, v97
v_cvt_pk_bf16_f32 v145, v98, v99
v_cvt_pk_bf16_f32 v146, v100, v101
v_cvt_pk_bf16_f32 v147, v102, v103
v_cvt_pk_bf16_f32 v148, v104, v105
v_cvt_pk_bf16_f32 v149, v106, v107
v_cvt_pk_bf16_f32 v150, v108, v109
v_cvt_pk_bf16_f32 v151, v110, v111
v_pk_add_f32 v[224:225], v[96:97], v[98:99]
v_pk_add_f32 v[226:227], v[100:101], v[102:103]
v_pk_add_f32 v[228:229], v[104:105], v[106:107]
v_pk_add_f32 v[230:231], v[108:109], v[110:111]
v_pk_add_f32 v[224:225], v[224:225], v[226:227]
v_pk_add_f32 v[228:229], v[228:229], v[230:231]
ds_read_b128 v[96:99], v235
ds_read_b128 v[100:103], v235 offset:16
ds_read_b128 v[104:107], v235 offset:64
ds_read_b128 v[108:111], v235 offset:80
v_add_u32 v235, 512, v235
s_waitcnt vmcnt(2)
buffer_load_dwordx4 v[192:195], v236, s[24:27], 0 offen offset:1024 nt
s_waitcnt lgkmcnt(4)
v_mfma_f32_32x32x16_bf16 v[0:15], v[112:115], v[144:147], v[0:15]
v_mfma_f32_32x32x16_bf16 v[16:31], v[116:119], v[144:147], v[16:31]
v_mfma_f32_32x32x16_bf16 v[32:47], v[120:123], v[144:147], v[32:47]
v_mfma_f32_32x32x16_bf16 v[48:63], v[124:127], v[144:147], v[48:63]
v_pk_add_f32 v[224:225], v[224:225], v[228:229]
v_pk_add_f32 v[218:219], v[218:219], v[224:225]
v_mfma_f32_32x32x16_bf16 v[0:15], v[128:131], v[148:151], v[0:15]
v_mfma_f32_32x32x16_bf16 v[16:31], v[132:135], v[148:151], v[16:31]
v_mfma_f32_32x32x16_bf16 v[32:47], v[136:139], v[148:151], v[32:47]
v_mfma_f32_32x32x16_bf16 v[48:63], v[140:143], v[148:151], v[48:63]
s_waitcnt vmcnt(2)
buffer_load_dwordx4 v[196:199], v236, s[24:27], 0 offen offset:1536 nt
v_add_u32 v236, 0x8000, v236
s_waitcnt lgkmcnt(0)
s_barrier
s_waitcnt vmcnt(4) lgkmcnt(0)
s_waitcnt vmcnt(2)
buffer_load_dwordx4 v[200:203], v237, s[24:27], 0 offen offset:0 nt
v_cvt_f32_i32 v152, v152
v_cvt_f32_i32 v153, v153
v_cvt_f32_i32 v154, v154
v_cvt_f32_i32 v155, v155
v_pk_fma_f32 v[152:153], v[152:153], v[96:97], v[100:101] op_sel:[0,0,0] op_sel_hi:[1,0,0]
v_pk_fma_f32 v[154:155], v[154:155], v[96:97], v[100:101] op_sel:[0,0,0] op_sel_hi:[1,0,0]
v_cvt_f32_i32 v156, v156
v_cvt_f32_i32 v157, v157
v_cvt_f32_i32 v158, v158
v_cvt_f32_i32 v159, v159
v_pk_fma_f32 v[156:157], v[156:157], v[96:97], v[100:101] op_sel:[0,1,1] op_sel_hi:[1,1,1]
v_pk_fma_f32 v[158:159], v[158:159], v[96:97], v[100:101] op_sel:[0,1,1] op_sel_hi:[1,1,1]
v_cvt_pk_bf16_f32 v112, v152, v156
v_cvt_pk_bf16_f32 v116, v153, v157
v_cvt_pk_bf16_f32 v120, v154, v158
v_cvt_pk_bf16_f32 v124, v155, v159
v_cvt_f32_i32 v160, v160
v_cvt_f32_i32 v161, v161
v_cvt_f32_i32 v162, v162
v_cvt_f32_i32 v163, v163
v_pk_fma_f32 v[160:161], v[160:161], v[98:99], v[102:103] op_sel:[0,0,0] op_sel_hi:[1,0,0]
v_pk_fma_f32 v[162:163], v[162:163], v[98:99], v[102:103] op_sel:[0,0,0] op_sel_hi:[1,0,0]
v_cvt_f32_i32 v164, v164
v_cvt_f32_i32 v165, v165
v_cvt_f32_i32 v166, v166
v_cvt_f32_i32 v167, v167
v_pk_fma_f32 v[164:165], v[164:165], v[98:99], v[102:103] op_sel:[0,1,1] op_sel_hi:[1,1,1]
v_pk_fma_f32 v[166:167], v[166:167], v[98:99], v[102:103] op_sel:[0,1,1] op_sel_hi:[1,1,1]
v_cvt_pk_bf16_f32 v113, v160, v164
v_cvt_pk_bf16_f32 v117, v161, v165
v_cvt_pk_bf16_f32 v121, v162, v166
v_cvt_pk_bf16_f32 v125, v163, v167
s_waitcnt vmcnt(2)
buffer_load_dwordx4 v[204:207], v237, s[24:27], 0 offen offset:512 nt
v_cvt_f32_i32 v168, v168
v_cvt_f32_i32 v169, v169
v_cvt_f32_i32 v170, v170
v_cvt_f32_i32 v171, v171
v_pk_fma_f32 v[168:169], v[168:169], v[104:105], v[108:109] op_sel:[0,0,0] op_sel_hi:[1,0,0]
v_pk_fma_f32 v[170:171], v[170:171], v[104:105], v[108:109] op_sel:[0,0,0] op_sel_hi:[1,0,0]
v_cvt_f32_i32 v172, v172
v_cvt_f32_i32 v173, v173
v_cvt_f32_i32 v174, v174
v_cvt_f32_i32 v175, v175
v_pk_fma_f32 v[172:173], v[172:173], v[104:105], v[108:109] op_sel:[0,1,1] op_sel_hi:[1,1,1]
v_pk_fma_f32 v[174:175], v[174:175], v[104:105], v[108:109] op_sel:[0,1,1] op_sel_hi:[1,1,1]
v_cvt_pk_bf16_f32 v114, v168, v172
v_cvt_pk_bf16_f32 v118, v169, v173
v_cvt_pk_bf16_f32 v122, v170, v174
v_cvt_pk_bf16_f32 v126, v171, v175
v_cvt_f32_i32 v176, v176
v_cvt_f32_i32 v177, v177
v_cvt_f32_i32 v178, v178
v_cvt_f32_i32 v179, v179
v_pk_fma_f32 v[176:177], v[176:177], v[106:107], v[110:111] op_sel:[0,0,0] op_sel_hi:[1,0,0]
v_pk_fma_f32 v[178:179], v[178:179], v[106:107], v[110:111] op_sel:[0,0,0] op_sel_hi:[1,0,0]
v_cvt_f32_i32 v180, v180
v_cvt_f32_i32 v181, v181
v_cvt_f32_i32 v182, v182
v_cvt_f32_i32 v183, v183
v_pk_fma_f32 v[180:181], v[180:181], v[106:107], v[110:111] op_sel:[0,1,1] op_sel_hi:[1,1,1]
v_pk_fma_f32 v[182:183], v[182:183], v[106:107], v[110:111] op_sel:[0,1,1] op_sel_hi:[1,1,1]
v_cvt_pk_bf16_f32 v115, v176, v180
v_cvt_pk_bf16_f32 v119, v177, v181
v_cvt_pk_bf16_f32 v123, v178, v182
v_cvt_pk_bf16_f32 v127, v179, v183
ds_write_b128 v234, v[112:115] offset:17408
ds_write_b128 v234, v[116:119] offset:18432
ds_write_b128 v234, v[120:123] offset:19456
ds_write_b128 v234, v[124:127] offset:20480
s_waitcnt vmcnt(2)
buffer_load_dwordx4 v[208:211], v237, s[24:27], 0 offen offset:1024 nt
ds_read_b128 v[112:115], v232 offset:33792
ds_read_b128 v[116:119], v232 offset:33824
ds_read_b128 v[120:123], v232 offset:33856
ds_read_b128 v[124:127], v232 offset:33888
ds_read_b128 v[128:131], v232 offset:33920
ds_read_b128 v[132:135], v232 offset:33952
ds_read_b128 v[136:139], v232 offset:33984
ds_read_b128 v[140:143], v232 offset:34016
s_waitcnt vmcnt(2)
buffer_load_dwordx4 v[212:215], v237, s[24:27], 0 offen offset:1536 nt
v_add_u32 v237, 0x8000, v237
s_waitcnt lgkmcnt(7)
v_mfma_f32_32x32x16_bf16 v[96:111], v[112:115], v[64:67], 0
s_waitcnt lgkmcnt(6)
v_mfma_f32_32x32x16_bf16 v[96:111], v[116:119], v[68:71], v[96:111]
s_waitcnt lgkmcnt(5)
v_mfma_f32_32x32x16_bf16 v[96:111], v[120:123], v[72:75], v[96:111]
s_waitcnt lgkmcnt(4)
v_mfma_f32_32x32x16_bf16 v[96:111], v[124:127], v[76:79], v[96:111]
s_waitcnt lgkmcnt(3)
v_mfma_f32_32x32x16_bf16 v[96:111], v[128:131], v[80:83], v[96:111]
s_waitcnt lgkmcnt(2)
v_mfma_f32_32x32x16_bf16 v[96:111], v[132:135], v[84:87], v[96:111]
s_waitcnt lgkmcnt(1)
v_mfma_f32_32x32x16_bf16 v[96:111], v[136:139], v[88:91], v[96:111]
s_waitcnt lgkmcnt(0)
v_mfma_f32_32x32x16_bf16 v[96:111], v[140:143], v[92:95], v[96:111]
ds_read_b128 v[112:115], v233 offset:51200
ds_read_b128 v[116:119], v233 offset:52224
ds_read_b128 v[120:123], v233 offset:53248
ds_read_b128 v[124:127], v233 offset:54272
ds_read_b128 v[128:131], v233 offset:55296
ds_read_b128 v[132:135], v233 offset:56320
ds_read_b128 v[136:139], v233 offset:57344
ds_read_b128 v[140:143], v233 offset:58368
s_waitcnt vmcnt(2)
buffer_load_dwordx4 v[152:155], v236, s[24:27], 0 offen offset:0 nt
s_nop 1
v_max3_f32 v224, v96, v97, v98
v_max3_f32 v225, v99, v100, v101
v_max3_f32 v226, v102, v103, v104
v_max3_f32 v227, v105, v106, v107
v_max3_f32 v224, v224, v108, v109
v_max3_f32 v225, v225, v110, v111
v_max3_f32 v224, v224, v226, v227
v_max_f32 v224, v224, v225
v_cmp_gt_f32 vcc, v224, v221
s_nop 1
s_cbranch_vccz L_nr6
v_max_f32 v224, v224, v216
v_mov_b32 v225, v224
s_nop 1
v_permlane32_swap_b32 v224, v225
s_nop 0
v_max_f32 v224, v224, v225
v_sub_f32 v226, v216, v224
v_mul_f32 v226, s40, v226
v_mul_f32 v220, s44, v224
v_exp_f32 v222, v226
v_mov_b32 v216, v224
v_add_f32 v221, s45, v224
v_pk_mul_f32 v[218:219], v[218:219], v[222:223] op_sel_hi:[1,0]
v_pk_mul_f32 v[0:1], v[0:1], v[222:223] op_sel_hi:[1,0]
v_pk_mul_f32 v[2:3], v[2:3], v[222:223] op_sel_hi:[1,0]
v_pk_mul_f32 v[4:5], v[4:5], v[222:223] op_sel_hi:[1,0]
v_pk_mul_f32 v[6:7], v[6:7], v[222:223] op_sel_hi:[1,0]
v_pk_mul_f32 v[8:9], v[8:9], v[222:223] op_sel_hi:[1,0]
v_pk_mul_f32 v[10:11], v[10:11], v[222:223] op_sel_hi:[1,0]
v_pk_mul_f32 v[12:13], v[12:13], v[222:223] op_sel_hi:[1,0]
v_pk_mul_f32 v[14:15], v[14:15], v[222:223] op_sel_hi:[1,0]
v_pk_mul_f32 v[16:17], v[16:17], v[222:223] op_sel_hi:[1,0]
v_pk_mul_f32 v[18:19], v[18:19], v[222:223] op_sel_hi:[1,0]
v_pk_mul_f32 v[20:21], v[20:21], v[222:223] op_sel_hi:[1,0]
v_pk_mul_f32 v[22:23], v[22:23], v[222:223] op_sel_hi:[1,0]
v_pk_mul_f32 v[24:25], v[24:25], v[222:223] op_sel_hi:[1,0]
v_pk_mul_f32 v[26:27], v[26:27], v[222:223] op_sel_hi:[1,0]
v_pk_mul_f32 v[28:29], v[28:29], v[222:223] op_sel_hi:[1,0]
v_pk_mul_f32 v[30:31], v[30:31], v[222:223] op_sel_hi:[1,0]
v_pk_mul_f32 v[32:33], v[32:33], v[222:223] op_sel_hi:[1,0]
v_pk_mul_f32 v[34:35], v[34:35], v[222:223] op_sel_hi:[1,0]
v_pk_mul_f32 v[36:37], v[36:37], v[222:223] op_sel_hi:[1,0]
v_pk_mul_f32 v[38:39], v[38:39], v[222:223] op_sel_hi:[1,0]
v_pk_mul_f32 v[40:41], v[40:41], v[222:223] op_sel_hi:[1,0]
v_pk_mul_f32 v[42:43], v[42:43], v[222:223] op_sel_hi:[1,0]
v_pk_mul_f32 v[44:45], v[44:45], v[222:223] op_sel_hi:[1,0]
v_pk_mul_f32 v[46:47], v[46:47], v[222:223] op_sel_hi:[1,0]
v_pk_mul_f32 v[48:49], v[48:49], v[222:223] op_sel_hi:[1,0]
v_pk_mul_f32 v[50:51], v[50:51], v[222:223] op_sel_hi:[1,0]
v_pk_mul_f32 v[52:53], v[52:53], v[222:223] op_sel_hi:[1,0]
v_pk_mul_f32 v[54:55], v[54:55], v[222:223] op_sel_hi:[1,0]
v_pk_mul_f32 v[56:57], v[56:57], v[222:223] op_sel_hi:[1,0]
v_pk_mul_f32 v[58:59], v[58:59], v[222:223] op_sel_hi:[1,0]
v_pk_mul_f32 v[60:61], v[60:61], v[222:223] op_sel_hi:[1,0]
v_pk_mul_f32 v[62:63], v[62:63], v[222:223] op_sel_hi:[1,0]
L_nr6:
v_pk_fma_f32 v[96:97], v[96:97], s[40:41], v[220:221] op_sel_hi:[1,1,0]
v_pk_fma_f32 v[98:99], v[98:99], s[40:41], v[220:221] op_sel_hi:[1,1,0]
v_pk_fma_f32 v[100:101], v[100:101], s[40:41], v[220:221] op_sel_hi:[1,1,0]
v_pk_fma_f32 v[102:103], v[102:103], s[40:41], v[220:221] op_sel_hi:[1,1,0]
v_pk_fma_f32 v[104:105], v[104:105], s[40:41], v[220:221] op_sel_hi:[1,1,0]
v_pk_fma_f32 v[106:107], v[106:107], s[40:41], v[220:221] op_sel_hi:[1,1,0]
v_pk_fma_f32 v[108:109], v[108:109], s[40:41], v[220:221] op_sel_hi:[1,1,0]
v_pk_fma_f32 v[110:111], v[110:111], s[40:41], v[220:221] op_sel_hi:[1,1,0]
v_exp_f32 v96, v96
v_exp_f32 v97, v97
v_exp_f32 v98, v98
v_exp_f32 v99, v99
v_exp_f32 v100, v100
v_exp_f32 v101, v101
v_exp_f32 v102, v102
v_exp_f32 v103, v103
v_exp_f32 v104, v104
v_exp_f32 v105, v105
v_exp_f32 v106, v106
v_exp_f32 v107, v107
v_exp_f32 v108, v108
v_exp_f32 v109, v109
v_exp_f32 v110, v110
v_exp_f32 v111, v111
s_waitcnt vmcnt(2)
buffer_load_dwordx4 v[156:159], v236, s[24:27], 0 offen offset:512 nt
v_cvt_pk_bf16_f32 v144, v96, v97
v_cvt_pk_bf16_f32 v145, v98, v99
v_cvt_pk_bf16_f32 v146, v100, v101
v_cvt_pk_bf16_f32 v147, v102, v103
v_cvt_pk_bf16_f32 v148, v104, v105
v_cvt_pk_bf16_f32 v149, v106, v107
v_cvt_pk_bf16_f32 v150, v108, v109
v_cvt_pk_bf16_f32 v151, v110, v111
v_pk_add_f32 v[224:225], v[96:97], v[98:99]
v_pk_add_f32 v[226:227], v[100:101], v[102:103]
v_pk_add_f32 v[228:229], v[104:105], v[106:107]
v_pk_add_f32 v[230:231], v[108:109], v[110:111]
v_pk_add_f32 v[224:225], v[224:225], v[226:227]
v_pk_add_f32 v[228:229], v[228:229], v[230:231]
ds_read_b128 v[96:99], v235
ds_read_b128 v[100:103], v235 offset:16
ds_read_b128 v[104:107], v235 offset:64
ds_read_b128 v[108:111], v235 offset:80
v_add_u32 v235, 512, v235
s_waitcnt vmcnt(2)
buffer_load_dwordx4 v[160:163], v236, s[24:27], 0 offen offset:1024 nt
s_waitcnt lgkmcnt(4)
v_mfma_f32_32x32x16_bf16 v[0:15], v[112:115], v[144:147], v[0:15]
v_mfma_f32_32x32x16_bf16 v[16:31], v[116:119], v[144:147], v[16:31]
v_mfma_f32_32x32x16_bf16 v[32:47], v[120:123], v[144:147], v[32:47]
v_mfma_f32_32x32x16_bf16 v[48:63], v[124:127], v[144:147], v[48:63]
v_pk_add_f32 v[224:225], v[224:225], v[228:229]
v_pk_add_f32 v[218:219], v[218:219], v[224:225]
v_mfma_f32_32x32x16_bf16 v[0:15], v[128:131], v[148:151], v[0:15]
v_mfma_f32_32x32x16_bf16 v[16:31], v[132:135], v[148:151], v[16:31]
v_mfma_f32_32x32x16_bf16 v[32:47], v[136:139], v[148:151], v[32:47]
v_mfma_f32_32x32x16_bf16 v[48:63], v[140:143], v[148:151], v[48:63]
s_waitcnt vmcnt(2)
buffer_load_dwordx4 v[164:167], v236, s[24:27], 0 offen offset:1536 nt
v_add_u32 v236, 0x8000, v236
s_waitcnt lgkmcnt(0)
s_barrier
s_sub_u32 s42, s42, 1
s_cmp_lg_u32 s42, 0
s_cbranch_scc1 L_V_loop
s_waitcnt vmcnt(4) lgkmcnt(0)
v_cvt_f32_i32 v184, v184
v_cvt_f32_i32 v185, v185
v_cvt_f32_i32 v186, v186
v_cvt_f32_i32 v187, v187
v_pk_fma_f32 v[184:185], v[184:185], v[96:97], v[100:101] op_sel:[0,0,0] op_sel_hi:[1,0,0]
v_pk_fma_f32 v[186:187], v[186:187], v[96:97], v[100:101] op_sel:[0,0,0] op_sel_hi:[1,0,0]
v_cvt_f32_i32 v188, v188
v_cvt_f32_i32 v189, v189
v_cvt_f32_i32 v190, v190
v_cvt_f32_i32 v191, v191
v_pk_fma_f32 v[188:189], v[188:189], v[96:97], v[100:101] op_sel:[0,1,1] op_sel_hi:[1,1,1]
v_pk_fma_f32 v[190:191], v[190:191], v[96:97], v[100:101] op_sel:[0,1,1] op_sel_hi:[1,1,1]
v_cvt_pk_bf16_f32 v112, v184, v188
v_cvt_pk_bf16_f32 v116, v185, v189
v_cvt_pk_bf16_f32 v120, v186, v190
v_cvt_pk_bf16_f32 v124, v187, v191
v_cvt_f32_i32 v192, v192
v_cvt_f32_i32 v193, v193
v_cvt_f32_i32 v194, v194
v_cvt_f32_i32 v195, v195
v_pk_fma_f32 v[192:193], v[192:193], v[98:99], v[102:103] op_sel:[0,0,0] op_sel_hi:[1,0,0]
v_pk_fma_f32 v[194:195], v[194:195], v[98:99], v[102:103] op_sel:[0,0,0] op_sel_hi:[1,0,0]
v_cvt_f32_i32 v196, v196
v_cvt_f32_i32 v197, v197
v_cvt_f32_i32 v198, v198
v_cvt_f32_i32 v199, v199
v_pk_fma_f32 v[196:197], v[196:197], v[98:99], v[102:103] op_sel:[0,1,1] op_sel_hi:[1,1,1]
v_pk_fma_f32 v[198:199], v[198:199], v[98:99], v[102:103] op_sel:[0,1,1] op_sel_hi:[1,1,1]
v_cvt_pk_bf16_f32 v113, v192, v196
v_cvt_pk_bf16_f32 v117, v193, v197
v_cvt_pk_bf16_f32 v121, v194, v198
v_cvt_pk_bf16_f32 v125, v195, v199
v_cvt_f32_i32 v200, v200
v_cvt_f32_i32 v201, v201
v_cvt_f32_i32 v202, v202
v_cvt_f32_i32 v203, v203
v_pk_fma_f32 v[200:201], v[200:201], v[104:105], v[108:109] op_sel:[0,0,0] op_sel_hi:[1,0,0]
v_pk_fma_f32 v[202:203], v[202:203], v[104:105], v[108:109] op_sel:[0,0,0] op_sel_hi:[1,0,0]
v_cvt_f32_i32 v204, v204
v_cvt_f32_i32 v205, v205
v_cvt_f32_i32 v206, v206
v_cvt_f32_i32 v207, v207
v_pk_fma_f32 v[204:205], v[204:205], v[104:105], v[108:109] op_sel:[0,1,1] op_sel_hi:[1,1,1]
v_pk_fma_f32 v[206:207], v[206:207], v[104:105], v[108:109] op_sel:[0,1,1] op_sel_hi:[1,1,1]
v_cvt_pk_bf16_f32 v114, v200, v204
v_cvt_pk_bf16_f32 v118, v201, v205
v_cvt_pk_bf16_f32 v122, v202, v206
v_cvt_pk_bf16_f32 v126, v203, v207
v_cvt_f32_i32 v208, v208
v_cvt_f32_i32 v209, v209
v_cvt_f32_i32 v210, v210
v_cvt_f32_i32 v211, v211
v_pk_fma_f32 v[208:209], v[208:209], v[106:107], v[110:111] op_sel:[0,0,0] op_sel_hi:[1,0,0]
v_pk_fma_f32 v[210:211], v[210:211], v[106:107], v[110:111] op_sel:[0,0,0] op_sel_hi:[1,0,0]
v_cvt_f32_i32 v212, v212
v_cvt_f32_i32 v213, v213
v_cvt_f32_i32 v214, v214
v_cvt_f32_i32 v215, v215
v_pk_fma_f32 v[212:213], v[212:213], v[106:107], v[110:111] op_sel:[0,1,1] op_sel_hi:[1,1,1]
v_pk_fma_f32 v[214:215], v[214:215], v[106:107], v[110:111] op_sel:[0,1,1] op_sel_hi:[1,1,1]
v_cvt_pk_bf16_f32 v115, v208, v212
v_cvt_pk_bf16_f32 v119, v209, v213
v_cvt_pk_bf16_f32 v123, v210, v214
v_cvt_pk_bf16_f32 v127, v211, v215
ds_write_b128 v234, v[112:115] offset:51200
ds_write_b128 v234, v[116:119] offset:52224
ds_write_b128 v234, v[120:123] offset:53248
ds_write_b128 v234, v[124:127] offset:54272
ds_read_b128 v[112:115], v232 offset:0
ds_read_b128 v[116:119], v232 offset:32
ds_read_b128 v[120:123], v232 offset:64
ds_read_b128 v[124:127], v232 offset:96
ds_read_b128 v[128:131], v232 offset:128
ds_read_b128 v[132:135], v232 offset:160
ds_read_b128 v[136:139], v232 offset:192
ds_read_b128 v[140:143], v232 offset:224
s_waitcnt lgkmcnt(7)
v_mfma_f32_32x32x16_bf16 v[96:111], v[112:115], v[64:67], 0
s_waitcnt lgkmcnt(6)
v_mfma_f32_32x32x16_bf16 v[96:111], v[116:119], v[68:71], v[96:111]
s_waitcnt lgkmcnt(5)
v_mfma_f32_32x32x16_bf16 v[96:111], v[120:123], v[72:75], v[96:111]
s_waitcnt lgkmcnt(4)
v_mfma_f32_32x32x16_bf16 v[96:111], v[124:127], v[76:79], v[96:111]
s_waitcnt lgkmcnt(3)
v_mfma_f32_32x32x16_bf16 v[96:111], v[128:131], v[80:83], v[96:111]
s_waitcnt lgkmcnt(2)
v_mfma_f32_32x32x16_bf16 v[96:111], v[132:135], v[84:87], v[96:111]
s_waitcnt lgkmcnt(1)
v_mfma_f32_32x32x16_bf16 v[96:111], v[136:139], v[88:91], v[96:111]
s_waitcnt lgkmcnt(0)
v_mfma_f32_32x32x16_bf16 v[96:111], v[140:143], v[92:95], v[96:111]
ds_read_b128 v[112:115], v233 offset:17408
ds_read_b128 v[116:119], v233 offset:18432
ds_read_b128 v[120:123], v233 offset:19456
ds_read_b128 v[124:127], v233 offset:20480
ds_read_b128 v[128:131], v233 offset:21504
ds_read_b128 v[132:135], v233 offset:22528
ds_read_b128 v[136:139], v233 offset:23552
ds_read_b128 v[140:143], v233 offset:24576
s_nop 3
v_max3_f32 v224, v96, v97, v98
v_max3_f32 v225, v99, v100, v101
v_max3_f32 v226, v102, v103, v104
v_max3_f32 v227, v105, v106, v107
v_max3_f32 v224, v224, v108, v109
v_max3_f32 v225, v225, v110, v111
v_max3_f32 v224, v224, v226, v227
v_max_f32 v224, v224, v225
v_cmp_gt_f32 vcc, v224, v221
s_nop 1
s_cbranch_vccz L_nr7
v_max_f32 v224, v224, v216
v_mov_b32 v225, v224
s_nop 1
v_permlane32_swap_b32 v224, v225
s_nop 0
v_max_f32 v224, v224, v225
v_sub_f32 v226, v216, v224
v_mul_f32 v226, s40, v226
v_mul_f32 v220, s44, v224
v_exp_f32 v222, v226
v_mov_b32 v216, v224
v_add_f32 v221, s45, v224
v_pk_mul_f32 v[218:219], v[218:219], v[222:223] op_sel_hi:[1,0]
v_pk_mul_f32 v[0:1], v[0:1], v[222:223] op_sel_hi:[1,0]
v_pk_mul_f32 v[2:3], v[2:3], v[222:223] op_sel_hi:[1,0]
v_pk_mul_f32 v[4:5], v[4:5], v[222:223] op_sel_hi:[1,0]
v_pk_mul_f32 v[6:7], v[6:7], v[222:223] op_sel_hi:[1,0]
v_pk_mul_f32 v[8:9], v[8:9], v[222:223] op_sel_hi:[1,0]
v_pk_mul_f32 v[10:11], v[10:11], v[222:223] op_sel_hi:[1,0]
v_pk_mul_f32 v[12:13], v[12:13], v[222:223] op_sel_hi:[1,0]
v_pk_mul_f32 v[14:15], v[14:15], v[222:223] op_sel_hi:[1,0]
v_pk_mul_f32 v[16:17], v[16:17], v[222:223] op_sel_hi:[1,0]
v_pk_mul_f32 v[18:19], v[18:19], v[222:223] op_sel_hi:[1,0]
v_pk_mul_f32 v[20:21], v[20:21], v[222:223] op_sel_hi:[1,0]
v_pk_mul_f32 v[22:23], v[22:23], v[222:223] op_sel_hi:[1,0]
v_pk_mul_f32 v[24:25], v[24:25], v[222:223] op_sel_hi:[1,0]
v_pk_mul_f32 v[26:27], v[26:27], v[222:223] op_sel_hi:[1,0]
v_pk_mul_f32 v[28:29], v[28:29], v[222:223] op_sel_hi:[1,0]
v_pk_mul_f32 v[30:31], v[30:31], v[222:223] op_sel_hi:[1,0]
v_pk_mul_f32 v[32:33], v[32:33], v[222:223] op_sel_hi:[1,0]
v_pk_mul_f32 v[34:35], v[34:35], v[222:223] op_sel_hi:[1,0]
v_pk_mul_f32 v[36:37], v[36:37], v[222:223] op_sel_hi:[1,0]
v_pk_mul_f32 v[38:39], v[38:39], v[222:223] op_sel_hi:[1,0]
v_pk_mul_f32 v[40:41], v[40:41], v[222:223] op_sel_hi:[1,0]
v_pk_mul_f32 v[42:43], v[42:43], v[222:223] op_sel_hi:[1,0]
v_pk_mul_f32 v[44:45], v[44:45], v[222:223] op_sel_hi:[1,0]
v_pk_mul_f32 v[46:47], v[46:47], v[222:223] op_sel_hi:[1,0]
v_pk_mul_f32 v[48:49], v[48:49], v[222:223] op_sel_hi:[1,0]
v_pk_mul_f32 v[50:51], v[50:51], v[222:223] op_sel_hi:[1,0]
v_pk_mul_f32 v[52:53], v[52:53], v[222:223] op_sel_hi:[1,0]
v_pk_mul_f32 v[54:55], v[54:55], v[222:223] op_sel_hi:[1,0]
v_pk_mul_f32 v[56:57], v[56:57], v[222:223] op_sel_hi:[1,0]
v_pk_mul_f32 v[58:59], v[58:59], v[222:223] op_sel_hi:[1,0]
v_pk_mul_f32 v[60:61], v[60:61], v[222:223] op_sel_hi:[1,0]
v_pk_mul_f32 v[62:63], v[62:63], v[222:223] op_sel_hi:[1,0]
L_nr7:
v_pk_fma_f32 v[96:97], v[96:97], s[40:41], v[220:221] op_sel_hi:[1,1,0]
v_pk_fma_f32 v[98:99], v[98:99], s[40:41], v[220:221] op_sel_hi:[1,1,0]
v_pk_fma_f32 v[100:101], v[100:101], s[40:41], v[220:221] op_sel_hi:[1,1,0]
v_pk_fma_f32 v[102:103], v[102:103], s[40:41], v[220:221] op_sel_hi:[1,1,0]
v_pk_fma_f32 v[104:105], v[104:105], s[40:41], v[220:221] op_sel_hi:[1,1,0]
v_pk_fma_f32 v[106:107], v[106:107], s[40:41], v[220:221] op_sel_hi:[1,1,0]
v_pk_fma_f32 v[108:109], v[108:109], s[40:41], v[220:221] op_sel_hi:[1,1,0]
v_pk_fma_f32 v[110:111], v[110:111], s[40:41], v[220:221] op_sel_hi:[1,1,0]
v_exp_f32 v96, v96
v_exp_f32 v97, v97
v_exp_f32 v98, v98
v_exp_f32 v99, v99
v_exp_f32 v100, v100
v_exp_f32 v101, v101
v_exp_f32 v102, v102
v_exp_f32 v103, v103
v_exp_f32 v104, v104
v_exp_f32 v105, v105
v_exp_f32 v106, v106
v_exp_f32 v107, v107
v_exp_f32 v108, v108
v_exp_f32 v109, v109
v_exp_f32 v110, v110
v_exp_f32 v111, v111
v_cvt_pk_bf16_f32 v144, v96, v97
v_cvt_pk_bf16_f32 v145, v98, v99
v_cvt_pk_bf16_f32 v146, v100, v101
v_cvt_pk_bf16_f32 v147, v102, v103
v_cvt_pk_bf16_f32 v148, v104, v105
v_cvt_pk_bf16_f32 v149, v106, v107
v_cvt_pk_bf16_f32 v150, v108, v109
v_cvt_pk_bf16_f32 v151, v110, v111
v_pk_add_f32 v[224:225], v[96:97], v[98:99]
v_pk_add_f32 v[226:227], v[100:101], v[102:103]
v_pk_add_f32 v[228:229], v[104:105], v[106:107]
v_pk_add_f32 v[230:231], v[108:109], v[110:111]
v_pk_add_f32 v[224:225], v[224:225], v[226:227]
v_pk_add_f32 v[228:229], v[228:229], v[230:231]
s_waitcnt lgkmcnt(0)
v_mfma_f32_32x32x16_bf16 v[0:15], v[112:115], v[144:147], v[0:15]
v_mfma_f32_32x32x16_bf16 v[16:31], v[116:119], v[144:147], v[16:31]
v_mfma_f32_32x32x16_bf16 v[32:47], v[120:123], v[144:147], v[32:47]
v_mfma_f32_32x32x16_bf16 v[48:63], v[124:127], v[144:147], v[48:63]
v_pk_add_f32 v[224:225], v[224:225], v[228:229]
v_pk_add_f32 v[218:219], v[218:219], v[224:225]
v_mfma_f32_32x32x16_bf16 v[0:15], v[128:131], v[148:151], v[0:15]
v_mfma_f32_32x32x16_bf16 v[16:31], v[132:135], v[148:151], v[16:31]
v_mfma_f32_32x32x16_bf16 v[32:47], v[136:139], v[148:151], v[32:47]
v_mfma_f32_32x32x16_bf16 v[48:63], v[140:143], v[148:151], v[48:63]
s_waitcnt lgkmcnt(0)
s_barrier
ds_read_b128 v[112:115], v232 offset:33792
ds_read_b128 v[116:119], v232 offset:33824
ds_read_b128 v[120:123], v232 offset:33856
ds_read_b128 v[124:127], v232 offset:33888
ds_read_b128 v[128:131], v232 offset:33920
ds_read_b128 v[132:135], v232 offset:33952
ds_read_b128 v[136:139], v232 offset:33984
ds_read_b128 v[140:143], v232 offset:34016
s_waitcnt lgkmcnt(7)
v_mfma_f32_32x32x16_bf16 v[96:111], v[112:115], v[64:67], 0
s_waitcnt lgkmcnt(6)
v_mfma_f32_32x32x16_bf16 v[96:111], v[116:119], v[68:71], v[96:111]
s_waitcnt lgkmcnt(5)
v_mfma_f32_32x32x16_bf16 v[96:111], v[120:123], v[72:75], v[96:111]
s_waitcnt lgkmcnt(4)
v_mfma_f32_32x32x16_bf16 v[96:111], v[124:127], v[76:79], v[96:111]
s_waitcnt lgkmcnt(3)
v_mfma_f32_32x32x16_bf16 v[96:111], v[128:131], v[80:83], v[96:111]
s_waitcnt lgkmcnt(2)
v_mfma_f32_32x32x16_bf16 v[96:111], v[132:135], v[84:87], v[96:111]
s_waitcnt lgkmcnt(1)
v_mfma_f32_32x32x16_bf16 v[96:111], v[136:139], v[88:91], v[96:111]
s_waitcnt lgkmcnt(0)
v_mfma_f32_32x32x16_bf16 v[96:111], v[140:143], v[92:95], v[96:111]
ds_read_b128 v[112:115], v233 offset:51200
ds_read_b128 v[116:119], v233 offset:52224
ds_read_b128 v[120:123], v233 offset:53248
ds_read_b128 v[124:127], v233 offset:54272
ds_read_b128 v[128:131], v233 offset:55296
ds_read_b128 v[132:135], v233 offset:56320
ds_read_b128 v[136:139], v233 offset:57344
ds_read_b128 v[140:143], v233 offset:58368
s_nop 3
v_max3_f32 v224, v96, v97, v98
v_max3_f32 v225, v99, v100, v101
v_max3_f32 v226, v102, v103, v104
v_max3_f32 v227, v105, v106, v107
v_max3_f32 v224, v224, v108, v109
v_max3_f32 v225, v225, v110, v111
v_max3_f32 v224, v224, v226, v227
v_max_f32 v224, v224, v225
v_cmp_gt_f32 vcc, v224, v221
s_nop 1
s_cbranch_vccz L_nr8
v_max_f32 v224, v224, v216
v_mov_b32 v225, v224
s_nop 1
v_permlane32_swap_b32 v224, v225
s_nop 0
v_max_f32 v224, v224, v225
v_sub_f32 v226, v216, v224
v_mul_f32 v226, s40, v226
v_mul_f32 v220, s44, v224
v_exp_f32 v222, v226
v_mov_b32 v216, v224
v_add_f32 v221, s45, v224
v_pk_mul_f32 v[218:219], v[218:219], v[222:223] op_sel_hi:[1,0]
v_pk_mul_f32 v[0:1], v[0:1], v[222:223] op_sel_hi:[1,0]
v_pk_mul_f32 v[2:3], v[2:3], v[222:223] op_sel_hi:[1,0]
v_pk_mul_f32 v[4:5], v[4:5], v[222:223] op_sel_hi:[1,0]
v_pk_mul_f32 v[6:7], v[6:7], v[222:223] op_sel_hi:[1,0]
v_pk_mul_f32 v[8:9], v[8:9], v[222:223] op_sel_hi:[1,0]
v_pk_mul_f32 v[10:11], v[10:11], v[222:223] op_sel_hi:[1,0]
v_pk_mul_f32 v[12:13], v[12:13], v[222:223] op_sel_hi:[1,0]
v_pk_mul_f32 v[14:15], v[14:15], v[222:223] op_sel_hi:[1,0]
v_pk_mul_f32 v[16:17], v[16:17], v[222:223] op_sel_hi:[1,0]
v_pk_mul_f32 v[18:19], v[18:19], v[222:223] op_sel_hi:[1,0]
v_pk_mul_f32 v[20:21], v[20:21], v[222:223] op_sel_hi:[1,0]
v_pk_mul_f32 v[22:23], v[22:23], v[222:223] op_sel_hi:[1,0]
v_pk_mul_f32 v[24:25], v[24:25], v[222:223] op_sel_hi:[1,0]
v_pk_mul_f32 v[26:27], v[26:27], v[222:223] op_sel_hi:[1,0]
v_pk_mul_f32 v[28:29], v[28:29], v[222:223] op_sel_hi:[1,0]
v_pk_mul_f32 v[30:31], v[30:31], v[222:223] op_sel_hi:[1,0]
v_pk_mul_f32 v[32:33], v[32:33], v[222:223] op_sel_hi:[1,0]
v_pk_mul_f32 v[34:35], v[34:35], v[222:223] op_sel_hi:[1,0]
v_pk_mul_f32 v[36:37], v[36:37], v[222:223] op_sel_hi:[1,0]
v_pk_mul_f32 v[38:39], v[38:39], v[222:223] op_sel_hi:[1,0]
v_pk_mul_f32 v[40:41], v[40:41], v[222:223] op_sel_hi:[1,0]
v_pk_mul_f32 v[42:43], v[42:43], v[222:223] op_sel_hi:[1,0]
v_pk_mul_f32 v[44:45], v[44:45], v[222:223] op_sel_hi:[1,0]
v_pk_mul_f32 v[46:47], v[46:47], v[222:223] op_sel_hi:[1,0]
v_pk_mul_f32 v[48:49], v[48:49], v[222:223] op_sel_hi:[1,0]
v_pk_mul_f32 v[50:51], v[50:51], v[222:223] op_sel_hi:[1,0]
v_pk_mul_f32 v[52:53], v[52:53], v[222:223] op_sel_hi:[1,0]
v_pk_mul_f32 v[54:55], v[54:55], v[222:223] op_sel_hi:[1,0]
v_pk_mul_f32 v[56:57], v[56:57], v[222:223] op_sel_hi:[1,0]
v_pk_mul_f32 v[58:59], v[58:59], v[222:223] op_sel_hi:[1,0]
v_pk_mul_f32 v[60:61], v[60:61], v[222:223] op_sel_hi:[1,0]
v_pk_mul_f32 v[62:63], v[62:63], v[222:223] op_sel_hi:[1,0]
L_nr8:
v_pk_fma_f32 v[96:97], v[96:97], s[40:41], v[220:221] op_sel_hi:[1,1,0]
v_pk_fma_f32 v[98:99], v[98:99], s[40:41], v[220:221] op_sel_hi:[1,1,0]
v_pk_fma_f32 v[100:101], v[100:101], s[40:41], v[220:221] op_sel_hi:[1,1,0]
v_pk_fma_f32 v[102:103], v[102:103], s[40:41], v[220:221] op_sel_hi:[1,1,0]
v_pk_fma_f32 v[104:105], v[104:105], s[40:41], v[220:221] op_sel_hi:[1,1,0]
v_pk_fma_f32 v[106:107], v[106:107], s[40:41], v[220:221] op_sel_hi:[1,1,0]
v_pk_fma_f32 v[108:109], v[108:109], s[40:41], v[220:221] op_sel_hi:[1,1,0]
v_pk_fma_f32 v[110:111], v[110:111], s[40:41], v[220:221] op_sel_hi:[1,1,0]
v_exp_f32 v96, v96
v_exp_f32 v97, v97
v_exp_f32 v98, v98
v_exp_f32 v99, v99
v_exp_f32 v100, v100
v_exp_f32 v101, v101
v_exp_f32 v102, v102
v_exp_f32 v103, v103
v_exp_f32 v104, v104
v_exp_f32 v105, v105
v_exp_f32 v106, v106
v_exp_f32 v107, v107
v_exp_f32 v108, v108
v_exp_f32 v109, v109
v_exp_f32 v110, v110
v_exp_f32 v111, v111
v_cvt_pk_bf16_f32 v144, v96, v97
v_cvt_pk_bf16_f32 v145, v98, v99
v_cvt_pk_bf16_f32 v146, v100, v101
v_cvt_pk_bf16_f32 v147, v102, v103
v_cvt_pk_bf16_f32 v148, v104, v105
v_cvt_pk_bf16_f32 v149, v106, v107
v_cvt_pk_bf16_f32 v150, v108, v109
v_cvt_pk_bf16_f32 v151, v110, v111
v_pk_add_f32 v[224:225], v[96:97], v[98:99]
v_pk_add_f32 v[226:227], v[100:101], v[102:103]
v_pk_add_f32 v[228:229], v[104:105], v[106:107]
v_pk_add_f32 v[230:231], v[108:109], v[110:111]
v_pk_add_f32 v[224:225], v[224:225], v[226:227]
v_pk_add_f32 v[228:229], v[228:229], v[230:231]
s_waitcnt lgkmcnt(0)
v_mfma_f32_32x32x16_bf16 v[0:15], v[112:115], v[144:147], v[0:15]
v_mfma_f32_32x32x16_bf16 v[16:31], v[116:119], v[144:147], v[16:31]
v_mfma_f32_32x32x16_bf16 v[32:47], v[120:123], v[144:147], v[32:47]
v_mfma_f32_32x32x16_bf16 v[48:63], v[124:127], v[144:147], v[48:63]
v_pk_add_f32 v[224:225], v[224:225], v[228:229]
v_pk_add_f32 v[218:219], v[218:219], v[224:225]
v_mfma_f32_32x32x16_bf16 v[0:15], v[128:131], v[148:151], v[0:15]
v_mfma_f32_32x32x16_bf16 v[16:31], v[132:135], v[148:151], v[16:31]
v_mfma_f32_32x32x16_bf16 v[32:47], v[136:139], v[148:151], v[32:47]
v_mfma_f32_32x32x16_bf16 v[48:63], v[140:143], v[148:151], v[48:63]
v_add_f32 v217, v218, v219
v_mov_b32 v224, v217
s_nop 1
v_permlane32_swap_b32 v217, v224
s_nop 0
v_add_f32 v217, v217, v224
s_mul_i32 s56, s3, 8704
s_add_u32 s56, s56, 68608
s_xor_b32 s58, s3, 4
s_mul_i32 s57, s58, 8704
s_add_u32 s57, s57, 68608
v_lshlrev_b32 v225, 4, v238
v_add_u32 v226, s56, v225
v_add_u32 v227, s57, v225
v_lshlrev_b32 v225, 3, v238
v_add_u32 v228, s56, v225
v_add_u32 v229, s57, v225
s_lshl_b32 s56, s36, 5
s_add_u32 s56, s56, s3
s_mul_i32 s56, s56, 4608
s_add_u32 s28, s22, s56
s_addc_u32 s29, s23, 0
s_mov_b32 s30, 115200
s_mov_b32 s31, 0x20000
ds_write_b128 v226, v[0:3] offset:0
ds_write_b128 v226, v[4:7] offset:1024
ds_write_b128 v226, v[16:19] offset:2048
ds_write_b128 v226, v[20:23] offset:3072
ds_write_b128 v226, v[32:35] offset:4096
ds_write_b128 v226, v[36:39] offset:5120
ds_write_b128 v226, v[48:51] offset:6144
ds_write_b128 v226, v[52:55] offset:7168
ds_write_b64 v228, v[216:217] offset:8192
s_waitcnt vmcnt(0)
s_waitcnt lgkmcnt(0)
s_barrier
ds_read_b32 v243, v250
ds_read_b128 v[112:115], v227 offset:0
ds_read_b128 v[116:119], v227 offset:1024
ds_read_b128 v[120:123], v227 offset:2048
ds_read_b128 v[124:127], v227 offset:3072
ds_read_b128 v[128:131], v227 offset:4096
ds_read_b128 v[132:135], v227 offset:5120
ds_read_b128 v[136:139], v227 offset:6144
ds_read_b128 v[140:143], v227 offset:7168
ds_read_b64 v[246:247], v229 offset:8192
s_waitcnt lgkmcnt(9)
v_readfirstlane_b32 s58, v243
s_cmp_lt_u32 s58, 3
s_cbranch_scc1 L_V_nold
v_lshlrev_b32 v224, 4, v238
v_lshlrev_b32 v225, 3, v238
v_add_u32 v225, 4096, v225
s_add_u32 s56, s37, 1
s_and_b32 s56, s56, 3
s_mul_i32 s88, s56, 36864
v_add_u32 v244, s88, v225
buffer_load_dwordx2 v[144:145], v244, s[28:31], 0 offen sc1
s_add_u32 s56, s37, 2
s_and_b32 s56, s56, 3
s_mul_i32 s89, s56, 36864
v_add_u32 v244, s89, v225
buffer_load_dwordx2 v[146:147], v244, s[28:31], 0 offen sc1
s_add_u32 s56, s37, 3
s_and_b32 s56, s56, 3
s_mul_i32 s90, s56, 36864
v_add_u32 v244, s90, v225
buffer_load_dwordx2 v[148:149], v244, s[28:31], 0 offen sc1
v_add_u32 v242, s88, v224
buffer_load_dwordx4 v[152:155], v242, s[28:31], 0 offen offset:0 sc1
buffer_load_dwordx4 v[156:159], v242, s[28:31], 0 offen offset:1024 sc1
buffer_load_dwordx4 v[160:163], v242, s[28:31], 0 offen offset:2048 sc1
buffer_load_dwordx4 v[164:167], v242, s[28:31], 0 offen offset:3072 sc1
v_add_u32 v242, s89, v224
buffer_load_dwordx4 v[168:171], v242, s[28:31], 0 offen offset:0 sc1
buffer_load_dwordx4 v[172:175], v242, s[28:31], 0 offen offset:1024 sc1
buffer_load_dwordx4 v[176:179], v242, s[28:31], 0 offen offset:2048 sc1
buffer_load_dwordx4 v[180:183], v242, s[28:31], 0 offen offset:3072 sc1
v_add_u32 v242, s90, v224
buffer_load_dwordx4 v[184:187], v242, s[28:31], 0 offen offset:0 sc1
buffer_load_dwordx4 v[188:191], v242, s[28:31], 0 offen offset:1024 sc1
buffer_load_dwordx4 v[192:195], v242, s[28:31], 0 offen offset:2048 sc1
buffer_load_dwordx4 v[196:199], v242, s[28:31], 0 offen offset:3072 sc1
L_V_nold:
s_waitcnt lgkmcnt(0)
v_max_f32 v224, v216, v246
v_sub_f32 v226, v216, v224
v_sub_f32 v228, v246, v224
v_mul_f32 v226, s40, v226
v_mul_f32 v228, s40, v228
v_exp_f32 v226, v226
v_exp_f32 v228, v228
v_mov_b32 v216, v224
v_mul_f32 v217, v217, v226
v_fmac_f32 v217, v247, v228
v_pk_mul_f32 v[8:9], v[8:9], v[226:227] op_sel_hi:[1,0]
v_pk_fma_f32 v[8:9], v[112:113], v[228:229], v[8:9] op_sel_hi:[1,0,1]
v_pk_mul_f32 v[10:11], v[10:11], v[226:227] op_sel_hi:[1,0]
v_pk_fma_f32 v[10:11], v[114:115], v[228:229], v[10:11] op_sel_hi:[1,0,1]
v_pk_mul_f32 v[12:13], v[12:13], v[226:227] op_sel_hi:[1,0]
v_pk_fma_f32 v[12:13], v[116:117], v[228:229], v[12:13] op_sel_hi:[1,0,1]
v_pk_mul_f32 v[14:15], v[14:15], v[226:227] op_sel_hi:[1,0]
v_pk_fma_f32 v[14:15], v[118:119], v[228:229], v[14:15] op_sel_hi:[1,0,1]
v_pk_mul_f32 v[24:25], v[24:25], v[226:227] op_sel_hi:[1,0]
v_pk_fma_f32 v[24:25], v[120:121], v[228:229], v[24:25] op_sel_hi:[1,0,1]
v_pk_mul_f32 v[26:27], v[26:27], v[226:227] op_sel_hi:[1,0]
v_pk_fma_f32 v[26:27], v[122:123], v[228:229], v[26:27] op_sel_hi:[1,0,1]
v_pk_mul_f32 v[28:29], v[28:29], v[226:227] op_sel_hi:[1,0]
v_pk_fma_f32 v[28:29], v[124:125], v[228:229], v[28:29] op_sel_hi:[1,0,1]
v_pk_mul_f32 v[30:31], v[30:31], v[226:227] op_sel_hi:[1,0]
v_pk_fma_f32 v[30:31], v[126:127], v[228:229], v[30:31] op_sel_hi:[1,0,1]
v_pk_mul_f32 v[40:41], v[40:41], v[226:227] op_sel_hi:[1,0]
v_pk_fma_f32 v[40:41], v[128:129], v[228:229], v[40:41] op_sel_hi:[1,0,1]
v_pk_mul_f32 v[42:43], v[42:43], v[226:227] op_sel_hi:[1,0]
v_pk_fma_f32 v[42:43], v[130:131], v[228:229], v[42:43] op_sel_hi:[1,0,1]
v_pk_mul_f32 v[44:45], v[44:45], v[226:227] op_sel_hi:[1,0]
v_pk_fma_f32 v[44:45], v[132:133], v[228:229], v[44:45] op_sel_hi:[1,0,1]
v_pk_mul_f32 v[46:47], v[46:47], v[226:227] op_sel_hi:[1,0]
v_pk_fma_f32 v[46:47], v[134:135], v[228:229], v[46:47] op_sel_hi:[1,0,1]
v_pk_mul_f32 v[56:57], v[56:57], v[226:227] op_sel_hi:[1,0]
v_pk_fma_f32 v[56:57], v[136:137], v[228:229], v[56:57] op_sel_hi:[1,0,1]
v_pk_mul_f32 v[58:59], v[58:59], v[226:227] op_sel_hi:[1,0]
v_pk_fma_f32 v[58:59], v[138:139], v[228:229], v[58:59] op_sel_hi:[1,0,1]
v_pk_mul_f32 v[60:61], v[60:61], v[226:227] op_sel_hi:[1,0]
v_pk_fma_f32 v[60:61], v[140:141], v[228:229], v[60:61] op_sel_hi:[1,0,1]
v_pk_mul_f32 v[62:63], v[62:63], v[226:227] op_sel_hi:[1,0]
v_pk_fma_f32 v[62:63], v[142:143], v[228:229], v[62:63] op_sel_hi:[1,0,1]
s_cmp_ge_u32 s58, 3
s_cbranch_scc1 L_V_comb
s_mul_i32 s56, s37, 36864
v_lshlrev_b32 v224, 4, v238
v_add_u32 v224, s56, v224
v_lshlrev_b32 v226, 3, v238
v_add_u32 v226, s56, v226
v_add_u32 v226, 4096, v226
buffer_store_dwordx2 v[216:217], v226, s[28:31], 0 offen sc1
v_cvt_pk_bf16_f32 v112, v8, v9
v_cvt_pk_bf16_f32 v113, v10, v11
v_cvt_pk_bf16_f32 v114, v12, v13
v_cvt_pk_bf16_f32 v115, v14, v15
buffer_store_dwordx4 v[112:115], v224, s[28:31], 0 offen offset:0 sc1
v_cvt_pk_bf16_f32 v116, v24, v25
v_cvt_pk_bf16_f32 v117, v26, v27
v_cvt_pk_bf16_f32 v118, v28, v29
v_cvt_pk_bf16_f32 v119, v30, v31
buffer_store_dwordx4 v[116:119], v224, s[28:31], 0 offen offset:1024 sc1
v_cvt_pk_bf16_f32 v120, v40, v41
v_cvt_pk_bf16_f32 v121, v42, v43
v_cvt_pk_bf16_f32 v122, v44, v45
v_cvt_pk_bf16_f32 v123, v46, v47
buffer_store_dwordx4 v[120:123], v224, s[28:31], 0 offen offset:2048 sc1
v_cvt_pk_bf16_f32 v124, v56, v57
v_cvt_pk_bf16_f32 v125, v58, v59
v_cvt_pk_bf16_f32 v126, v60, v61
v_cvt_pk_bf16_f32 v127, v62, v63
buffer_store_dwordx4 v[124:127], v224, s[28:31], 0 offen offset:3072 sc1
s_waitcnt vmcnt(0)
s_barrier
s_barrier
ds_read_b32 v243, v250 offset:4
s_waitcnt lgkmcnt(0)
v_readfirstlane_b32 s58, v243
s_cmp_ge_u32 s58, 3
s_cbranch_scc1 L_V_late
s_endpgm
L_V_late:
v_lshlrev_b32 v224, 4, v238
v_lshlrev_b32 v225, 3, v238
v_add_u32 v225, 4096, v225
s_add_u32 s56, s37, 1
s_and_b32 s56, s56, 3
s_mul_i32 s88, s56, 36864
v_add_u32 v244, s88, v225
buffer_load_dwordx2 v[144:145], v244, s[28:31], 0 offen sc1
s_add_u32 s56, s37, 2
s_and_b32 s56, s56, 3
s_mul_i32 s89, s56, 36864
v_add_u32 v244, s89, v225
buffer_load_dwordx2 v[146:147], v244, s[28:31], 0 offen sc1
s_add_u32 s56, s37, 3
s_and_b32 s56, s56, 3
s_mul_i32 s90, s56, 36864
v_add_u32 v244, s90, v225
buffer_load_dwordx2 v[148:149], v244, s[28:31], 0 offen sc1
v_add_u32 v242, s88, v224
buffer_load_dwordx4 v[152:155], v242, s[28:31], 0 offen offset:0 sc1
buffer_load_dwordx4 v[156:159], v242, s[28:31], 0 offen offset:1024 sc1
buffer_load_dwordx4 v[160:163], v242, s[28:31], 0 offen offset:2048 sc1
buffer_load_dwordx4 v[164:167], v242, s[28:31], 0 offen offset:3072 sc1
v_add_u32 v242, s89, v224
buffer_load_dwordx4 v[168:171], v242, s[28:31], 0 offen offset:0 sc1
buffer_load_dwordx4 v[172:175], v242, s[28:31], 0 offen offset:1024 sc1
buffer_load_dwordx4 v[176:179], v242, s[28:31], 0 offen offset:2048 sc1
buffer_load_dwordx4 v[180:183], v242, s[28:31], 0 offen offset:3072 sc1
v_add_u32 v242, s90, v224
buffer_load_dwordx4 v[184:187], v242, s[28:31], 0 offen offset:0 sc1
buffer_load_dwordx4 v[188:191], v242, s[28:31], 0 offen offset:1024 sc1
buffer_load_dwordx4 v[192:195], v242, s[28:31], 0 offen offset:2048 sc1
buffer_load_dwordx4 v[196:199], v242, s[28:31], 0 offen offset:3072 sc1
L_V_comb:
s_add_u32 s32, s18, s43
s_addc_u32 s33, s19, 0
s_mov_b32 s34, 32768
s_mov_b32 s35, 0x20000
s_lshl_b32 s56, s38, 13
v_lshlrev_b32 v239, 8, v240
v_lshl_add_u32 v239, v241, 5, v239
v_add_u32 v239, s56, v239
s_waitcnt vmcnt(12)
v_max3_f32 v224, v216, v144, v146
v_max_f32 v224, v224, v148
v_sub_f32 v242, v216, v224
v_sub_f32 v244, v144, v224
v_sub_f32 v246, v146, v224
v_sub_f32 v248, v148, v224
v_mul_f32 v242, s40, v242
v_mul_f32 v244, s40, v244
v_mul_f32 v246, s40, v246
v_mul_f32 v248, s40, v248
v_exp_f32 v242, v242
v_exp_f32 v244, v244
v_exp_f32 v246, v246
v_exp_f32 v248, v248
s_nop 0
v_mul_f32 v217, v217, v242
v_fmac_f32 v217, v145, v244
v_fmac_f32 v217, v147, v246
v_fmac_f32 v217, v149, v248
v_rcp_f32 v224, v217
s_nop 0
v_mul_f32 v242, v242, v224
v_mul_f32 v244, v244, v224
v_mul_f32 v246, v246, v224
v_mul_f32 v248, v248, v224
v_pk_mul_f32 v[8:9], v[8:9], v[242:243] op_sel_hi:[1,0]
v_pk_mul_f32 v[10:11], v[10:11], v[242:243] op_sel_hi:[1,0]
v_pk_mul_f32 v[12:13], v[12:13], v[242:243] op_sel_hi:[1,0]
v_pk_mul_f32 v[14:15], v[14:15], v[242:243] op_sel_hi:[1,0]
v_pk_mul_f32 v[24:25], v[24:25], v[242:243] op_sel_hi:[1,0]
v_pk_mul_f32 v[26:27], v[26:27], v[242:243] op_sel_hi:[1,0]
v_pk_mul_f32 v[28:29], v[28:29], v[242:243] op_sel_hi:[1,0]
v_pk_mul_f32 v[30:31], v[30:31], v[242:243] op_sel_hi:[1,0]
v_pk_mul_f32 v[40:41], v[40:41], v[242:243] op_sel_hi:[1,0]
v_pk_mul_f32 v[42:43], v[42:43], v[242:243] op_sel_hi:[1,0]
v_pk_mul_f32 v[44:45], v[44:45], v[242:243] op_sel_hi:[1,0]
v_pk_mul_f32 v[46:47], v[46:47], v[242:243] op_sel_hi:[1,0]
v_pk_mul_f32 v[56:57], v[56:57], v[242:243] op_sel_hi:[1,0]
v_pk_mul_f32 v[58:59], v[58:59], v[242:243] op_sel_hi:[1,0]
v_pk_mul_f32 v[60:61], v[60:61], v[242:243] op_sel_hi:[1,0]
v_pk_mul_f32 v[62:63], v[62:63], v[242:243] op_sel_hi:[1,0]
s_waitcnt vmcnt(8)
v_lshlrev_b32 v112, 16, v152
v_and_b32 v113, 0xffff0000, v152
v_lshlrev_b32 v114, 16, v153
v_and_b32 v115, 0xffff0000, v153
v_lshlrev_b32 v116, 16, v154
v_and_b32 v117, 0xffff0000, v154
v_lshlrev_b32 v118, 16, v155
v_and_b32 v119, 0xffff0000, v155
v_lshlrev_b32 v120, 16, v156
v_and_b32 v121, 0xffff0000, v156
v_lshlrev_b32 v122, 16, v157
v_and_b32 v123, 0xffff0000, v157
v_lshlrev_b32 v124, 16, v158
v_and_b32 v125, 0xffff0000, v158
v_lshlrev_b32 v126, 16, v159
v_and_b32 v127, 0xffff0000, v159
v_lshlrev_b32 v128, 16, v160
v_and_b32 v129, 0xffff0000, v160
v_lshlrev_b32 v130, 16, v161
v_and_b32 v131, 0xffff0000, v161
v_lshlrev_b32 v132, 16, v162
v_and_b32 v133, 0xffff0000, v162
v_lshlrev_b32 v134, 16, v163
v_and_b32 v135, 0xffff0000, v163
v_lshlrev_b32 v136, 16, v164
v_and_b32 v137, 0xffff0000, v164
v_lshlrev_b32 v138, 16, v165
v_and_b32 v139, 0xffff0000, v165
v_lshlrev_b32 v140, 16, v166
v_and_b32 v141, 0xffff0000, v166
v_lshlrev_b32 v142, 16, v167
v_and_b32 v143, 0xffff0000, v167
v_pk_fma_f32 v[8:9], v[112:113], v[244:245], v[8:9] op_sel_hi:[1,0,1]
v_pk_fma_f32 v[10:11], v[114:115], v[244:245], v[10:11] op_sel_hi:[1,0,1]
v_pk_fma_f32 v[12:13], v[116:117], v[244:245], v[12:13] op_sel_hi:[1,0,1]
v_pk_fma_f32 v[14:15], v[118:119], v[244:245], v[14:15] op_sel_hi:[1,0,1]
v_pk_fma_f32 v[24:25], v[120:121], v[244:245], v[24:25] op_sel_hi:[1,0,1]
v_pk_fma_f32 v[26:27], v[122:123], v[244:245], v[26:27] op_sel_hi:[1,0,1]
v_pk_fma_f32 v[28:29], v[124:125], v[244:245], v[28:29] op_sel_hi:[1,0,1]
v_pk_fma_f32 v[30:31], v[126:127], v[244:245], v[30:31] op_sel_hi:[1,0,1]
v_pk_fma_f32 v[40:41], v[128:129], v[244:245], v[40:41] op_sel_hi:[1,0,1]
v_pk_fma_f32 v[42:43], v[130:131], v[244:245], v[42:43] op_sel_hi:[1,0,1]
v_pk_fma_f32 v[44:45], v[132:133], v[244:245], v[44:45] op_sel_hi:[1,0,1]
v_pk_fma_f32 v[46:47], v[134:135], v[244:245], v[46:47] op_sel_hi:[1,0,1]
v_pk_fma_f32 v[56:57], v[136:137], v[244:245], v[56:57] op_sel_hi:[1,0,1]
v_pk_fma_f32 v[58:59], v[138:139], v[244:245], v[58:59] op_sel_hi:[1,0,1]
v_pk_fma_f32 v[60:61], v[140:141], v[244:245], v[60:61] op_sel_hi:[1,0,1]
v_pk_fma_f32 v[62:63], v[142:143], v[244:245], v[62:63] op_sel_hi:[1,0,1]
s_waitcnt vmcnt(4)
v_lshlrev_b32 v112, 16, v168
v_and_b32 v113, 0xffff0000, v168
v_lshlrev_b32 v114, 16, v169
v_and_b32 v115, 0xffff0000, v169
v_lshlrev_b32 v116, 16, v170
v_and_b32 v117, 0xffff0000, v170
v_lshlrev_b32 v118, 16, v171
v_and_b32 v119, 0xffff0000, v171
v_lshlrev_b32 v120, 16, v172
v_and_b32 v121, 0xffff0000, v172
v_lshlrev_b32 v122, 16, v173
v_and_b32 v123, 0xffff0000, v173
v_lshlrev_b32 v124, 16, v174
v_and_b32 v125, 0xffff0000, v174
v_lshlrev_b32 v126, 16, v175
v_and_b32 v127, 0xffff0000, v175
v_lshlrev_b32 v128, 16, v176
v_and_b32 v129, 0xffff0000, v176
v_lshlrev_b32 v130, 16, v177
v_and_b32 v131, 0xffff0000, v177
v_lshlrev_b32 v132, 16, v178
v_and_b32 v133, 0xffff0000, v178
v_lshlrev_b32 v134, 16, v179
v_and_b32 v135, 0xffff0000, v179
v_lshlrev_b32 v136, 16, v180
v_and_b32 v137, 0xffff0000, v180
v_lshlrev_b32 v138, 16, v181
v_and_b32 v139, 0xffff0000, v181
v_lshlrev_b32 v140, 16, v182
v_and_b32 v141, 0xffff0000, v182
v_lshlrev_b32 v142, 16, v183
v_and_b32 v143, 0xffff0000, v183
v_pk_fma_f32 v[8:9], v[112:113], v[246:247], v[8:9] op_sel_hi:[1,0,1]
v_pk_fma_f32 v[10:11], v[114:115], v[246:247], v[10:11] op_sel_hi:[1,0,1]
v_pk_fma_f32 v[12:13], v[116:117], v[246:247], v[12:13] op_sel_hi:[1,0,1]
v_pk_fma_f32 v[14:15], v[118:119], v[246:247], v[14:15] op_sel_hi:[1,0,1]
v_pk_fma_f32 v[24:25], v[120:121], v[246:247], v[24:25] op_sel_hi:[1,0,1]
v_pk_fma_f32 v[26:27], v[122:123], v[246:247], v[26:27] op_sel_hi:[1,0,1]
v_pk_fma_f32 v[28:29], v[124:125], v[246:247], v[28:29] op_sel_hi:[1,0,1]
v_pk_fma_f32 v[30:31], v[126:127], v[246:247], v[30:31] op_sel_hi:[1,0,1]
v_pk_fma_f32 v[40:41], v[128:129], v[246:247], v[40:41] op_sel_hi:[1,0,1]
v_pk_fma_f32 v[42:43], v[130:131], v[246:247], v[42:43] op_sel_hi:[1,0,1]
v_pk_fma_f32 v[44:45], v[132:133], v[246:247], v[44:45] op_sel_hi:[1,0,1]
v_pk_fma_f32 v[46:47], v[134:135], v[246:247], v[46:47] op_sel_hi:[1,0,1]
v_pk_fma_f32 v[56:57], v[136:137], v[246:247], v[56:57] op_sel_hi:[1,0,1]
v_pk_fma_f32 v[58:59], v[138:139], v[246:247], v[58:59] op_sel_hi:[1,0,1]
v_pk_fma_f32 v[60:61], v[140:141], v[246:247], v[60:61] op_sel_hi:[1,0,1]
v_pk_fma_f32 v[62:63], v[142:143], v[246:247], v[62:63] op_sel_hi:[1,0,1]
s_waitcnt vmcnt(0)
v_lshlrev_b32 v112, 16, v184
v_and_b32 v113, 0xffff0000, v184
v_lshlrev_b32 v114, 16, v185
v_and_b32 v115, 0xffff0000, v185
v_lshlrev_b32 v116, 16, v186
v_and_b32 v117, 0xffff0000, v186
v_lshlrev_b32 v118, 16, v187
v_and_b32 v119, 0xffff0000, v187
v_lshlrev_b32 v120, 16, v188
v_and_b32 v121, 0xffff0000, v188
v_lshlrev_b32 v122, 16, v189
v_and_b32 v123, 0xffff0000, v189
v_lshlrev_b32 v124, 16, v190
v_and_b32 v125, 0xffff0000, v190
v_lshlrev_b32 v126, 16, v191
v_and_b32 v127, 0xffff0000, v191
v_lshlrev_b32 v128, 16, v192
v_and_b32 v129, 0xffff0000, v192
v_lshlrev_b32 v130, 16, v193
v_and_b32 v131, 0xffff0000, v193
v_lshlrev_b32 v132, 16, v194
v_and_b32 v133, 0xffff0000, v194
v_lshlrev_b32 v134, 16, v195
v_and_b32 v135, 0xffff0000, v195
v_lshlrev_b32 v136, 16, v196
v_and_b32 v137, 0xffff0000, v196
v_lshlrev_b32 v138, 16, v197
v_and_b32 v139, 0xffff0000, v197
v_lshlrev_b32 v140, 16, v198
v_and_b32 v141, 0xffff0000, v198
v_lshlrev_b32 v142, 16, v199
v_and_b32 v143, 0xffff0000, v199
v_pk_fma_f32 v[8:9], v[112:113], v[248:249], v[8:9] op_sel_hi:[1,0,1]
v_pk_fma_f32 v[10:11], v[114:115], v[248:249], v[10:11] op_sel_hi:[1,0,1]
v_pk_fma_f32 v[12:13], v[116:117], v[248:249], v[12:13] op_sel_hi:[1,0,1]
v_pk_fma_f32 v[14:15], v[118:119], v[248:249], v[14:15] op_sel_hi:[1,0,1]
v_pk_fma_f32 v[24:25], v[120:121], v[248:249], v[24:25] op_sel_hi:[1,0,1]
v_pk_fma_f32 v[26:27], v[122:123], v[248:249], v[26:27] op_sel_hi:[1,0,1]
v_pk_fma_f32 v[28:29], v[124:125], v[248:249], v[28:29] op_sel_hi:[1,0,1]
v_pk_fma_f32 v[30:31], v[126:127], v[248:249], v[30:31] op_sel_hi:[1,0,1]
v_pk_fma_f32 v[40:41], v[128:129], v[248:249], v[40:41] op_sel_hi:[1,0,1]
v_pk_fma_f32 v[42:43], v[130:131], v[248:249], v[42:43] op_sel_hi:[1,0,1]
v_pk_fma_f32 v[44:45], v[132:133], v[248:249], v[44:45] op_sel_hi:[1,0,1]
v_pk_fma_f32 v[46:47], v[134:135], v[248:249], v[46:47] op_sel_hi:[1,0,1]
v_pk_fma_f32 v[56:57], v[136:137], v[248:249], v[56:57] op_sel_hi:[1,0,1]
v_pk_fma_f32 v[58:59], v[138:139], v[248:249], v[58:59] op_sel_hi:[1,0,1]
v_pk_fma_f32 v[60:61], v[140:141], v[248:249], v[60:61] op_sel_hi:[1,0,1]
v_pk_fma_f32 v[62:63], v[142:143], v[248:249], v[62:63] op_sel_hi:[1,0,1]
v_cvt_pk_bf16_f32 v96, v8, v24
v_cvt_pk_bf16_f32 v97, v40, v56
v_cvt_pk_bf16_f32 v98, v9, v25
v_cvt_pk_bf16_f32 v99, v41, v57
v_cvt_pk_bf16_f32 v100, v10, v26
v_cvt_pk_bf16_f32 v101, v42, v58
v_cvt_pk_bf16_f32 v102, v11, v27
v_cvt_pk_bf16_f32 v103, v43, v59
buffer_store_dwordx4 v[96:99], v239, s[32:35], 0 offen offset:128
buffer_store_dwordx4 v[100:103], v239, s[32:35], 0 offen offset:144
v_cvt_pk_bf16_f32 v104, v12, v28
v_cvt_pk_bf16_f32 v105, v44, v60
v_cvt_pk_bf16_f32 v106, v13, v29
v_cvt_pk_bf16_f32 v107, v45, v61
v_cvt_pk_bf16_f32 v108, v14, v30
v_cvt_pk_bf16_f32 v109, v46, v62
v_cvt_pk_bf16_f32 v110, v15, v31
v_cvt_pk_bf16_f32 v111, v47, v63
buffer_store_dwordx4 v[104:107], v239, s[32:35], 0 offen offset:192
buffer_store_dwordx4 v[108:111], v239, s[32:35], 0 offen offset:208
s_endpgm
L_end:
s_endpgm
.section .rodata,"a"
.p2align 6
.amdhsa_kernel standalone__kv_cache_quant_int4_int2_kv_with_per_channel_or_per_token_scales__sampling_kernel
  .amdhsa_next_free_vgpr 256
  .amdhsa_next_free_sgpr 96
  .amdhsa_accum_offset 256
  .amdhsa_float_denorm_mode_32 3
  .amdhsa_group_segment_fixed_size 0
  .amdhsa_kernarg_size 80
  .amdhsa_user_sgpr_count 2
  .amdhsa_user_sgpr_kernarg_segment_ptr 1
  .amdhsa_system_sgpr_workgroup_id_x 1
.end_amdhsa_kernel
```
